```python
import torch

def _softmax(x, axis=-1):
    return torch.softmax(x, dim=axis)
def _gelu(x):
    return torch.nn.functional.gelu(x, approximate="tanh")
def _silu(x):
    return torch.nn.functional.silu(x)
def _sigmoid(x):
    return torch.sigmoid(x)
def _layernorm(x, axis=-1, eps=1e-5):
    m = x.mean(dim=axis, keepdim=True)
    v = x.var(dim=axis, keepdim=True, unbiased=False)
    return (x - m) / torch.sqrt(v + eps)
def _scatter_add(tgt, idx, src, axis=0):
    return tgt.clone().index_add_(axis, idx, src)
def _segment_sum(src, seg, n):
    out = torch.zeros((n,) + src.shape[1:], dtype=src.dtype)
    return out.index_add_(0, seg, src)
def _pad(x, pw):
    flat = tuple(v for pair in reversed(pw) for v in pair)
    return torch.nn.functional.pad(x, flat)

kernel_name = 'concat_heads__sliding_block_cached__gqa_block_cached__decode'

def setup_inputs():

    _w = (lambda a: (lambda t: t.to(torch.bfloat16) if t.is_floating_point() else t)(torch.as_tensor(a)))
    def _A_setup():
        B, Sq, D = 8, 1, 512
        Hq, Hkv, Sk, Dh = 32, 8, 4096, 128
        assert Hq % Hkv == 0, (Hq, Hkv)
        return {
            "x": _w((lambda *s: torch.randn(*s, dtype=torch.bfloat16) * 0.8)(B, Sq, D)),
            "k_cache": _w((lambda *s: torch.randn(*s, dtype=torch.bfloat16) * 1.6)(B, Hkv, Sk, Dh)),
            "v_cache": _w((lambda *s: torch.randn(*s, dtype=torch.bfloat16) * 0.2)(B, Hkv, Sk, Dh)),
            "wq": _w((lambda *s: torch.randn(*s, dtype=torch.bfloat16) * 1.6)(D, Hq * Dh) * (D ** -0.5)),
            "wo": _w((lambda *s: torch.randn(*s, dtype=torch.bfloat16) * 0.2)(Hq * Dh, D) * ((Hq * Dh) ** -0.5)),
        }
    _A_in = _A_setup()

    def _B_setup():
        B, Sq, D = 8, 1, 512
        Hq, Hkv, Sk, Dh = 32, 8, 4096, 128
        assert Hq % Hkv == 0, (Hq, Hkv)
        return {
            "x": _w((lambda *s: torch.randn(*s, dtype=torch.bfloat16) * 0.8)(B, Sq, D)),
            "k_cache": _w((lambda *s: torch.randn(*s, dtype=torch.bfloat16) * 1.6)(B, Hkv, Sk, Dh)),
            "v_cache": _w((lambda *s: torch.randn(*s, dtype=torch.bfloat16) * 0.2)(B, Hkv, Sk, Dh)),
            "wq": _w((lambda *s: torch.randn(*s, dtype=torch.bfloat16) * 1.6)(D, Hq * Dh) * (D ** -0.5)),
            "wo": _w((lambda *s: torch.randn(*s, dtype=torch.bfloat16) * 0.2)(Hq * Dh, D) * ((Hq * Dh) ** -0.5)),
        }
    _B_in = _B_setup()

    return {
        "A_x": _A_in["x"],
        "A_k_cache": _A_in["k_cache"],
        "A_v_cache": _A_in["v_cache"],
        "A_wq": _A_in["wq"],
        "A_wo": _A_in["wo"],
        "B_x": _B_in["x"],
        "B_k_cache": _B_in["k_cache"],
        "B_v_cache": _B_in["v_cache"],
        "B_wq": _B_in["wq"],
        "B_wo": _B_in["wo"],
    }

def reference(A_x, A_k_cache, A_v_cache, A_wq, A_wo, B_x, B_k_cache, B_v_cache, B_wq, B_wo):
    def _A_ref(x, k_cache, v_cache, wq, wo):
        B, Sq, D = x.shape
        Hq, Dh = 32, 128
        Hkv, Sk = k_cache.shape[1], k_cache.shape[2]
        W = min(4096, max(256, Sk // 4))
        rep = Hq // Hkv
        q = (lambda x, *d: x.permute(*d))((x @ wq).reshape(B, Sq, Hq, Dh), 0, 2, 1, 3)
        k = (lambda x, n, axis: torch.repeat_interleave(x, n, dim=axis))(k_cache[:, :, Sk - W:, :], rep, axis=1)
        v = (lambda x, n, axis: torch.repeat_interleave(x, n, dim=axis))(v_cache[:, :, Sk - W:, :], rep, axis=1)
        scores = torch.einsum("bhqd,bhkd->bhqk", q, k) * (Dh ** -0.5)
        p = _softmax(scores, axis=-1)
        o = torch.einsum("bhqk,bhkd->bhqd", p, v)
        return (lambda x, *d: x.permute(*d))(o, 0, 2, 1, 3).reshape(B, Sq, Hq * Dh) @ wo

    def _B_ref(x, k_cache, v_cache, wq, wo):
        B, Sq, D = x.shape
        Hq, Dh = 32, 128
        Hkv = k_cache.shape[1]
        rep = Hq // Hkv
        q = (lambda x, *d: x.permute(*d))((x @ wq).reshape(B, Sq, Hq, Dh), 0, 2, 1, 3)
        k = (lambda x, n, axis: torch.repeat_interleave(x, n, dim=axis))(k_cache, rep, axis=1)
        v = (lambda x, n, axis: torch.repeat_interleave(x, n, dim=axis))(v_cache, rep, axis=1)
        scores = torch.einsum("bhqd,bhkd->bhqk", q, k) * (Dh ** -0.5)
        p = _softmax(scores, axis=-1)
        o = torch.einsum("bhqk,bhkd->bhqd", p, v)
        return (lambda x, *d: x.permute(*d))(o, 0, 2, 1, 3).reshape(B, Sq, Hq * Dh) @ wo

    a = _A_ref(A_x, A_k_cache, A_v_cache, A_wq, A_wo)
    b = _B_ref(B_x, B_k_cache, B_v_cache, B_wq, B_wo)
    return torch.concatenate([a, b], axis=-1)
```

```asm
; @launch grid=(256,1,1) block=(256,1,1) lds=64256
.amdgcn_target "amdgcn-amd-amdhsa--gfx950"
.text
.globl concat_heads__sliding_block_cached__gqa_block_cached__decode_kernel
.p2align 8
.type concat_heads__sliding_block_cached__gqa_block_cached__decode_kernel,@function
concat_heads__sliding_block_cached__gqa_block_cached__decode_kernel:
    s_bitcmp1_b32 s2, 7
    s_cselect_b32 s10, 64, 24
    s_load_dwordx2 s[48:49], s[0:1], s10
    v_and_b32 v5, 15, v0
    v_sub_u32 v8, v0, v5
    v_lshlrev_b32 v8, 12, v8
    v_lshl_or_b32 v8, v5, 4, v8
    s_and_b32 s9, s2, 7
    s_bfe_u32 s8, s2, 0x20005
    s_lshl2_add_u32 s13, s9, s8
    s_and_b32 s8, s2, 24
    s_lshl_b32 s8, s8, 9
    s_or_b32 s8, s8, s13
    s_mov_b32 s50, 0x400000
    s_mov_b32 s51, 0x20000
    v_lshl_add_u32 v8, s8, 8, v8
    s_movk_i32 s4, 0x2000
    s_waitcnt lgkmcnt(0)
    buffer_load_dwordx4 v[128:131], v8, s[48:51], 0 offen nt
    buffer_load_dwordx4 v[132:135], v8, s[48:51], s4 offen nt
    s_addk_i32 s4, 0x2000
    buffer_load_dwordx4 v[136:139], v8, s[48:51], s4 offen nt
    s_addk_i32 s4, 0x2000
    buffer_load_dwordx4 v[140:143], v8, s[48:51], s4 offen nt
    s_addk_i32 s4, 0x2000
    buffer_load_dwordx4 v[144:147], v8, s[48:51], s4 offen nt
    s_addk_i32 s4, 0x2000
    buffer_load_dwordx4 v[148:151], v8, s[48:51], s4 offen nt
    s_addk_i32 s4, 0x2000
    buffer_load_dwordx4 v[152:155], v8, s[48:51], s4 offen nt
    s_addk_i32 s4, 0x2000
    buffer_load_dwordx4 v[156:159], v8, s[48:51], s4 offen nt
    s_load_dwordx2 s[32:33], s[0:1], 48
    s_cmpk_ge_u32 s2, 256
    s_cbranch_scc1 L_end
    s_load_dwordx2 s[60:61], s[0:1], 96
    s_sub_u32 s10, s10, 24
    s_load_dwordx2 s[52:53], s[0:1], s10
    s_load_dwordx2 s[56:57], s[0:1], 32
    s_load_dwordx2 s[36:37], s[0:1], 8
    s_load_dwordx2 s[40:41], s[0:1], 16
    s_load_dwordx2 s[44:45], s[0:1], 56
    s_load_dwordx2 s[64:65], s[0:1], 80
    s_lshr_b32 s5, s2, 7
    v_readfirstlane_b32 s3, v0
    v_and_b32 v0, 63, v0
    v_lshrrev_b32 v6, 4, v0
    v_and_b32 v7, 1, v0
    v_lshlrev_b32 v5, 4, v7
    v_lshl_or_b32 v5, v6, 5, v5
    v_bfe_u32 v7, v0, 1, 1
    v_lshl_or_b32 v5, v7, 11, v5
    v_bfe_u32 v7, v0, 2, 1
    v_lshl_or_b32 v5, v7, 13, v5
    v_bfe_u32 v7, v0, 3, 1
    v_lshl_or_b32 v5, v7, 10, v5
    s_lshr_b32 s3, s3, 6
    s_lshr_b32 s12, s2, 5
    s_lshl3_add_u32 s8, s12, s9
    s_lshl_b32 s8, s8, 20
    s_bfe_u32 s11, s2, 0x20003
    s_lshl_b32 s10, s11, 15
    s_or_b32 s8, s8, s10
    s_lshl_b32 s10, s3, 8
    s_or_b32 s8, s8, s10
    s_bitcmp1_b32 s2, 0
    s_cselect_b32 s95, 4096, 0
    s_bitcmp1_b32 s2, 1
    s_cselect_b32 s10, 655360, 0
    s_xor_b32 s95, s95, s10
    s_bitcmp1_b32 s2, 2
    s_cselect_b32 s10, 921600, 0
    s_xor_b32 s95, s95, s10
    s_bitcmp1_b32 s2, 5
    s_cselect_b32 s10, 671744, 0
    s_xor_b32 s95, s95, s10
    s_bitcmp1_b32 s2, 6
    s_cselect_b32 s10, 937984, 0
    s_xor_b32 s95, s95, s10
    s_bitcmp1_b32 s2, 7
    s_cselect_b32 s10, 282624, 0
    s_xor_b32 s95, s95, s10
    s_mov_b32 s34, 0x4000000
    s_mov_b32 s35, 0x20000
    v_add_u32 v1, s8, v5
    s_waitcnt lgkmcnt(0)
    s_mov_b32 s10, 1048576
    s_load_dword s18, s[60:61], s10
    v_and_b32 v5, 15, v0
    v_lshl_add_u32 v2, v5, 4, s8
    v_bfe_u32 v7, v0, 4, 1
    v_lshl_or_b32 v2, v7, 13, v2
    v_bfe_u32 v7, v0, 5, 1
    v_lshl_or_b32 v2, v7, 10, v2
    s_or_b32 s100, s95, 0xC0000
    s_mov_b32 s54, 8192
    s_mov_b32 s55, 0x20000
    s_mov_b32 s38, 67108864
    s_mov_b32 s39, 0x20000
    s_mov_b32 s42, 67108864
    s_mov_b32 s43, 0x20000
    s_mov_b32 s46, 67108864
    s_mov_b32 s47, 0x20000
    s_mov_b32 s58, 4194304
    s_mov_b32 s59, 0x20000
    s_mov_b32 s62, 285229056
    s_mov_b32 s63, 0x20000
    s_mov_b32 s66, 16384
    s_mov_b32 s67, 0x20000
    s_lshl2_add_u32 s8, s11, s3
    s_lshl_b32 s8, s8, 6
    v_and_b32 v7, 7, v0
    v_lshlrev_b32 v9, 10, v7
    v_lshl_or_b32 v9, v6, 4, v9
    v_add_u32 v9, s8, v9
    s_getpc_b64 s[70:71]
L_pc:
    s_lshl_b32 s8, s3, 13
    v_lshl_add_u32 v10, v0, 7, s8
    v_min_u32 v10, L_code_end-L_pc-4, v10
    buffer_load_dwordx4 v[48:51], v9, s[52:55], 0 offen
    s_lshr_b32 s4, s2, 3
    s_cmp_lg_u32 s4, 1
    s_cbranch_scc1 L_nocw
    global_load_dword v52, v10, s[70:71]
L_nocw:
    s_lshl2_add_u32 s94, s5, s11
    s_lshl_b32 s10, s13, 17
    s_lshl_b32 s15, s94, 7
    s_or_b32 s10, s10, s15
    s_lshl_b32 s15, s3, 15
    s_or_b32 s10, s10, s15
    v_lshrrev_b32 v16, 3, v0
    v_lshlrev_b32 v15, 10, v16
    v_lshl_or_b32 v15, v7, 4, v15
    v_add_u32 v15, s10, v15
    s_mov_b32 s16, 0x05040100
    s_mov_b32 s17, 0x07060302
    s_mov_b32 s22, 0x7060500
    s_mov_b32 s23, 0x7060501
    s_mov_b32 s24, 0x7060502
    s_mov_b32 s25, 0x7060503
    s_mov_b32 s26, 0x3e0293ee
    s_mov_b32 s27, 0x3ffff
    s_mov_b32 s93, 0xffffff00
    s_mov_b32 s28, 0x4000
    s_mov_b32 s29, 0x8000
    s_mov_b32 s30, 0xc000
    s_mov_b32 s31, 0x80000
    v_lshrrev_b32 v4, 5, v0
    s_waitcnt vmcnt(7)
    buffer_load_dwordx4 a[0:3], v1, s[32:35], s95 offen offset:0 nt
    v_and_b32 v5, 31, v0
    v_lshlrev_b32 v5, 4, v5
    v_mul_u32_u24 v12, 560, v7
    v_lshl_add_u32 v12, v6, 7, v12
    s_mul_i32 s8, s3, 4480
    v_add_u32 v12, s8, v12
    v_mul_u32_u24 v14, 560, v4
    v_add_u32 v14, v14, v5
    s_mul_i32 s8, s3, 1120
    v_add_u32 v14, s8, v14
    s_lshl_b32 s8, s5, 19
    s_lshl_b32 s10, s13, 14
    s_or_b32 s8, s8, s10
    s_lshl_b32 s10, s11, 9
    s_or_b32 s8, s8, s10
    s_add_u32 s8, s8, 3145728
    v_lshl_or_b32 v17, v4, 11, v5
    v_add_u32 v17, s8, v17
    s_lshl_b32 s10, s3, 12
    v_add_u32 v13, s10, v17
    s_getreg_b32 s6, hwreg(HW_REG_XCC_ID, 0, 4)
    s_lshl_b32 s6, s6, 20
    s_add_u32 s6, s6, 1048576
    s_mov_b32 s101, 0
    s_waitcnt vmcnt(7)
    buffer_load_dwordx4 a[4:7], v1, s[32:35], s95 offen offset:128 nt
    s_lshl_b32 s8, s12, 11
    s_lshl_b32 s10, s9, 16
    s_or_b32 s8, s8, s10
    s_lshl_b32 s10, s3, 14
    s_or_b32 s8, s8, s10
    s_add_u32 s8, s8, 3145728
    v_lshl_or_b32 v11, v4, 19, v5
    v_add_u32 v11, s8, v11
    s_xor_b32 s14, s95, 4096
    s_waitcnt vmcnt(7)
    buffer_load_dwordx4 a[8:11], v1, s[32:35], s14 offen offset:0 nt
    s_waitcnt vmcnt(7)
    buffer_load_dwordx4 a[12:15], v1, s[32:35], s14 offen offset:128 nt
    s_xor_b32 s14, s95, 131072
    s_waitcnt vmcnt(6)
    buffer_load_dwordx4 a[16:19], v1, s[32:35], s14 offen offset:0 nt
    s_waitcnt vmcnt(6)
    buffer_load_dwordx4 a[20:23], v1, s[32:35], s14 offen offset:128 nt
    s_xor_b32 s14, s95, 135168
    s_waitcnt vmcnt(5)
    buffer_load_dwordx4 a[24:27], v1, s[32:35], s14 offen offset:0 nt
    s_waitcnt lgkmcnt(0)
    s_add_u32 s92, s18, 0x9E3779B1
    s_and_b32 s18, s92, 0xfefefefe
    s_or_b32 s18, s18, 0x01000100
    s_lshr_b32 s19, s18, 8
    s_lshr_b32 s20, s18, 16
    s_lshr_b32 s21, s18, 24
    s_or_b32 s99, s2, s3
    s_mov_b32 s98, 0
    v_mov_b32 v3, s18
    v_perm_b32 v64, v132, v128, s16
    v_perm_b32 v68, v132, v128, s17
    v_perm_b32 v72, v133, v129, s16
    v_perm_b32 v76, v133, v129, s17
    v_perm_b32 v80, v134, v130, s16
    v_perm_b32 v84, v134, v130, s17
    v_perm_b32 v88, v135, v131, s16
    v_perm_b32 v92, v135, v131, s17
    v_perm_b32 v65, v140, v136, s16
    v_perm_b32 v69, v140, v136, s17
    v_perm_b32 v73, v141, v137, s16
    v_perm_b32 v77, v141, v137, s17
    v_perm_b32 v81, v142, v138, s16
    v_perm_b32 v85, v142, v138, s17
    s_waitcnt vmcnt(5)
    buffer_load_dwordx4 a[28:31], v1, s[32:35], s14 offen offset:128 nt
    v_perm_b32 v89, v143, v139, s16
    v_perm_b32 v93, v143, v139, s17
    v_perm_b32 v66, v148, v144, s16
    v_perm_b32 v70, v148, v144, s17
    v_perm_b32 v74, v149, v145, s16
    v_perm_b32 v78, v149, v145, s17
    v_perm_b32 v82, v150, v146, s16
    v_perm_b32 v86, v150, v146, s17
    v_perm_b32 v90, v151, v147, s16
    v_perm_b32 v94, v151, v147, s17
    v_perm_b32 v67, v156, v152, s16
    v_perm_b32 v71, v156, v152, s17
    v_perm_b32 v75, v157, v153, s16
    v_perm_b32 v79, v157, v153, s17
    v_perm_b32 v83, v158, v154, s16
    v_perm_b32 v87, v158, v154, s17
    v_perm_b32 v91, v159, v155, s16
    v_perm_b32 v95, v159, v155, s17
    v_mfma_f32_16x16x32_bf16 v[96:99], v[64:67], v[48:51], 0
    v_mfma_f32_16x16x32_bf16 v[100:103], v[68:71], v[48:51], 0
    v_mfma_f32_16x16x32_bf16 v[104:107], v[72:75], v[48:51], 0
    v_mfma_f32_16x16x32_bf16 v[108:111], v[76:79], v[48:51], 0
    v_mfma_f32_16x16x32_bf16 v[112:115], v[80:83], v[48:51], 0
    v_mfma_f32_16x16x32_bf16 v[116:119], v[84:87], v[48:51], 0
    s_xor_b32 s14, s95, 524288
    s_waitcnt vmcnt(5)
    buffer_load_dwordx4 a[32:35], v1, s[32:35], s14 offen offset:0 nt
    v_mfma_f32_16x16x32_bf16 v[120:123], v[88:91], v[48:51], 0
    v_mfma_f32_16x16x32_bf16 v[124:127], v[92:95], v[48:51], 0
    s_mov_b32 exec_lo, 0x00ff00ff
    s_mov_b32 exec_hi, 0x00ff00ff
    ds_write_b128 v12, v[96:99] offset:0
    ds_write_b128 v12, v[100:103] offset:16
    ds_write_b128 v12, v[104:107] offset:32
    ds_write_b128 v12, v[108:111] offset:48
    ds_write_b128 v12, v[112:115] offset:64
    ds_write_b128 v12, v[116:119] offset:80
    ds_write_b128 v12, v[120:123] offset:96
    ds_write_b128 v12, v[124:127] offset:112
    s_mov_b64 exec, -1
    s_waitcnt lgkmcnt(0)
    s_barrier
    ds_read_b128 v[64:67], v14 offset:0
    ds_read_b128 v[68:71], v14 offset:4480
    ds_read_b128 v[72:75], v14 offset:8960
    ds_read_b128 v[76:79], v14 offset:13440
    s_lshl2_add_u32 s8, s9, s3
    s_lshl_b32 s8, s8, 8
    s_add_u32 s8, s8, 1081344
    s_lshr_b32 s10, s2, 3
    s_add_u32 s10, s10, s8
    v_mov_b32 v92, 0
    s_mov_b64 exec, 1
    buffer_store_byte v92, off, s[60:63], s10
    s_mov_b64 exec, -1
    s_waitcnt vmcnt(6)
    buffer_load_dwordx4 a[36:39], v1, s[32:35], s14 offen offset:128 nt
    s_waitcnt lgkmcnt(0)
    v_pk_add_f32 v[80:81], v[64:65], v[68:69]
    v_pk_add_f32 v[82:83], v[66:67], v[70:71]
    v_pk_add_f32 v[84:85], v[72:73], v[76:77]
    v_pk_add_f32 v[86:87], v[74:75], v[78:79]
    v_pk_add_f32 v[80:81], v[80:81], v[84:85]
    v_pk_add_f32 v[82:83], v[82:83], v[86:87]
    v_perm_b32 v88, v80, v3, s22
    v_perm_b32 v89, v81, v3, s23
    v_perm_b32 v90, v82, v3, s24
    v_perm_b32 v91, v83, v3, s25
    buffer_store_dwordx4 v[88:91], v13, s[60:63], s6 offen
    s_load_dwordx2 s[48:49], s[0:1], 72
    s_lshl2_add_u32 s10, s13, s3
    s_lshl_b32 s10, s10, 1
    v_add_u32 v7, s10, v4
    v_lshlrev_b32 v12, 6, v7
    v_add_u32 v12, 1114112, v12
    v_lshl_or_b32 v13, v7, 11, v5
    v_add_u32 v13, 2097152, v13
    v_bfe_u32 v7, v0, 3, 2
    v_lshlrev_b32 v10, 10, v4
    v_lshl_or_b32 v10, v7, 6, v10
    v_and_b32 v7, 7, v0
    s_xor_b32 s14, s95, 528384
    s_waitcnt vmcnt(7)
    buffer_load_dwordx4 a[40:43], v1, s[32:35], s14 offen offset:0 nt
    v_lshl_or_b32 v10, v7, 1, v10
    s_lshl_b32 s8, s3, 8
    v_add_u32 v10, s8, v10
    s_lshl3_add_u32 s10, s13, s94
    s_lshl2_add_u32 s10, s10, s3
    s_lshl_b32 s70, s10, 9
    s_add_u32 s71, s70, 0x80000
    s_lshl2_add_u32 s15, s13, s11
    s_lshl_b32 s10, s15, 7
    s_lshl_b32 s8, s5, 19
    s_or_b32 s10, s10, s8
    v_lshlrev_b32 v8, 16, v16
    v_lshl_or_b32 v8, v7, 4, v8
    v_add_u32 v8, s10, v8
    s_lshr_b32 s10, s15, 4
    s_lshl_b32 s10, s10, 7
    s_and_b32 s8, s15, 1
    s_lshl1_add_u32 s10, s8, s10
    s_and_b32 s8, s15, 12
    s_or_b32 s10, s10, s8
    s_lshl_b32 s8, s5, 10
    s_or_b32 s10, s10, s8
    s_bfe_u32 s8, s15, 0x10001
    s_lshl_b32 s8, s8, 13
    s_waitcnt vmcnt(7)
    buffer_load_dwordx4 a[44:47], v1, s[32:35], s14 offen offset:128 nt
    s_or_b32 s10, s10, s8
    v_lshlrev_b32 v9, 11, v6
    v_lshl_or_b32 v9, v7, 4, v9
    v_add_u32 v9, s10, v9
    v_mul_u32_u24 v14, 80, v7
    v_lshl_add_u32 v14, v16, 3, v14
    s_mul_i32 s8, s3, 5120
    v_add_u32 v14, s8, v14
    v_and_b32 v7, 3, v0
    v_lshlrev_b32 v7, 8, v7
    v_lshl_or_b32 v7, v6, 5, v7
    v_bfe_u32 v5, v0, 2, 1
    v_lshl_or_b32 v7, v5, 4, v7
    s_xor_b32 s14, s95, 655360
    s_waitcnt vmcnt(7)
    buffer_load_dwordx4 a[48:51], v1, s[32:35], s14 offen offset:0 nt
    s_waitcnt vmcnt(7)
    buffer_load_dwordx4 a[52:55], v1, s[32:35], s14 offen offset:128 nt
    s_xor_b32 s14, s95, 659456
    s_waitcnt vmcnt(7)
    buffer_load_dwordx4 a[56:59], v1, s[32:35], s14 offen offset:0 nt
    s_waitcnt lgkmcnt(0)
    s_mov_b32 s96, s18
    s_mov_b32 s97, s18
    s_cmp_lg_u32 s99, 0
    s_cbranch_scc1 L_np0
    s_load_dword s96, s[60:61], 524288
    s_load_dword s7, s[60:61], 567296
    s_load_dword s7, s[60:61], 549888
    s_load_dword s97, s[60:61], 532480
L_np0:
    s_waitcnt vmcnt(6)
    buffer_load_dwordx4 a[60:63], v1, s[32:35], s14 offen offset:128 nt
    s_xor_b32 s14, s95, 262144
    s_waitcnt vmcnt(5)
    buffer_load_dwordx4 a[64:67], v1, s[32:35], s14 offen offset:0 nt
    s_mov_b64 vcc, s[96:97]
    s_cmp_eq_u32 vcc_hi, s18
    s_cselect_b32 vcc_lo, vcc_lo, s18
    s_cmp_lg_u32 vcc_lo, s18
    s_addc_u32 s98, s98, 0
    s_waitcnt vmcnt(5)
    buffer_load_dwordx4 a[68:71], v1, s[32:35], s14 offen offset:128 nt
    s_mov_b64 vcc, s[96:97]
    s_cmp_eq_u32 vcc_hi, s18
    s_cselect_b32 vcc_lo, vcc_lo, s18
    s_cmp_lg_u32 vcc_lo, s18
    s_addc_u32 s98, s98, 0
    s_xor_b32 s14, s95, 266240
    s_waitcnt vmcnt(5)
    buffer_load_dwordx4 a[72:75], v1, s[32:35], s14 offen offset:0 nt
    s_mov_b64 vcc, s[96:97]
    s_cmp_eq_u32 vcc_hi, s18
    s_cselect_b32 vcc_lo, vcc_lo, s18
    s_cmp_lg_u32 vcc_lo, s18
    s_addc_u32 s98, s98, 0
    s_waitcnt vmcnt(5)
    buffer_load_dwordx4 a[76:79], v1, s[32:35], s14 offen offset:128 nt
    s_mov_b64 vcc, s[96:97]
    s_cmp_eq_u32 vcc_hi, s18
    s_cselect_b32 vcc_lo, vcc_lo, s18
    s_cmp_lg_u32 vcc_lo, s18
    s_addc_u32 s98, s98, 0
    s_xor_b32 s14, s95, 393216
    s_waitcnt vmcnt(5)
    buffer_load_dwordx4 a[80:83], v1, s[32:35], s14 offen offset:0 nt
    s_mov_b64 vcc, s[96:97]
    s_cmp_eq_u32 vcc_hi, s18
    s_cselect_b32 vcc_lo, vcc_lo, s18
    s_cmp_lg_u32 vcc_lo, s18
    s_addc_u32 s98, s98, 0
    s_waitcnt vmcnt(5)
    buffer_load_dwordx4 a[84:87], v1, s[32:35], s14 offen offset:128 nt
    s_waitcnt lgkmcnt(0)
    s_mov_b32 s96, s18
    s_mov_b32 s97, s18
    s_cmp_lg_u32 s99, 0
    s_cbranch_scc1 L_np1
    s_load_dword s96, s[60:61], 582400
    s_load_dword s7, s[60:61], 609024
    s_load_dword s7, s[60:61], 591616
    s_load_dword s97, s[60:61], 574208
L_np1:
    s_xor_b32 s14, s95, 397312
    s_waitcnt vmcnt(5)
    buffer_load_dwordx4 a[88:91], v1, s[32:35], s14 offen offset:0 nt
    s_waitcnt vmcnt(5)
    buffer_load_dwordx4 a[92:95], v1, s[32:35], s14 offen offset:128 nt
    s_mov_b64 vcc, s[96:97]
    s_cmp_eq_u32 vcc_hi, s18
    s_cselect_b32 vcc_lo, vcc_lo, s18
    s_cmp_lg_u32 vcc_lo, s18
    s_subb_u32 s98, s98, 0
    s_xor_b32 s14, s95, 786432
    s_waitcnt vmcnt(5)
    buffer_load_dwordx4 a[96:99], v1, s[32:35], s14 offen offset:0 nt
    s_mov_b64 vcc, s[96:97]
    s_cmp_eq_u32 vcc_hi, s18
    s_cselect_b32 vcc_lo, vcc_lo, s18
    s_cmp_lg_u32 vcc_lo, s18
    s_subb_u32 s98, s98, 0
    s_waitcnt vmcnt(5)
    buffer_load_dwordx4 a[100:103], v1, s[32:35], s14 offen offset:128 nt
    s_mov_b64 vcc, s[96:97]
    s_cmp_eq_u32 vcc_hi, s18
    s_cselect_b32 vcc_lo, vcc_lo, s18
    s_cmp_lg_u32 vcc_lo, s18
    s_subb_u32 s98, s98, 0
    s_xor_b32 s14, s95, 790528
    s_waitcnt vmcnt(5)
    buffer_load_dwordx4 a[104:107], v1, s[32:35], s14 offen offset:0 nt
    s_mov_b64 vcc, s[96:97]
    s_cmp_eq_u32 vcc_hi, s18
    s_cselect_b32 vcc_lo, vcc_lo, s18
    s_cmp_lg_u32 vcc_lo, s18
    s_subb_u32 s98, s98, 0
    s_waitcnt vmcnt(5)
    buffer_load_dwordx4 a[108:111], v1, s[32:35], s14 offen offset:128 nt
    s_mov_b64 vcc, s[96:97]
    s_cmp_eq_u32 vcc_hi, s18
    s_cselect_b32 vcc_lo, vcc_lo, s18
    s_cmp_lg_u32 vcc_lo, s18
    s_subb_u32 s98, s98, 0
    s_xor_b32 s14, s95, 917504
    s_waitcnt vmcnt(5)
    buffer_load_dwordx4 a[112:115], v1, s[32:35], s14 offen offset:0 nt
    s_waitcnt lgkmcnt(0)
    s_mov_b32 s96, s18
    s_mov_b32 s97, s18
    s_cmp_lg_u32 s99, 0
    s_cbranch_scc1 L_np2
    s_load_dword s96, s[60:61], 624128
    s_load_dword s7, s[60:61], 667136
    s_load_dword s7, s[60:61], 649728
    s_load_dword s97, s[60:61], 632320
L_np2:
    s_waitcnt vmcnt(5)
    buffer_load_dwordx4 a[116:119], v1, s[32:35], s14 offen offset:128 nt
    s_xor_b32 s14, s95, 921600
    s_waitcnt vmcnt(5)
    buffer_load_dwordx4 a[120:123], v1, s[32:35], s14 offen offset:0 nt
    s_mov_b64 vcc, s[96:97]
    s_cmp_eq_u32 vcc_hi, s18
    s_cselect_b32 vcc_lo, vcc_lo, s18
    s_cmp_lg_u32 vcc_lo, s18
    s_addc_u32 s98, s98, 0
    s_waitcnt vmcnt(5)
    buffer_load_dwordx4 a[124:127], v1, s[32:35], s14 offen offset:128 nt
    s_mov_b64 vcc, s[96:97]
    s_cmp_eq_u32 vcc_hi, s18
    s_cselect_b32 vcc_lo, vcc_lo, s18
    s_cmp_lg_u32 vcc_lo, s18
    s_addc_u32 s98, s98, 0
    s_xor_b32 s14, s95, 16384
    s_waitcnt vmcnt(5)
    buffer_load_dwordx4 a[128:131], v1, s[32:35], s14 offen offset:0 nt
    s_mov_b64 vcc, s[96:97]
    s_cmp_eq_u32 vcc_hi, s18
    s_cselect_b32 vcc_lo, vcc_lo, s18
    s_cmp_lg_u32 vcc_lo, s18
    s_addc_u32 s98, s98, 0
    s_waitcnt vmcnt(5)
    buffer_load_dwordx4 a[132:135], v1, s[32:35], s14 offen offset:128 nt
    s_mov_b64 vcc, s[96:97]
    s_cmp_eq_u32 vcc_hi, s18
    s_cselect_b32 vcc_lo, vcc_lo, s18
    s_cmp_lg_u32 vcc_lo, s18
    s_addc_u32 s98, s98, 0
    s_xor_b32 s14, s95, 20480
    s_waitcnt vmcnt(5)
    buffer_load_dwordx4 a[136:139], v1, s[32:35], s14 offen offset:0 nt
    s_mov_b64 vcc, s[96:97]
    s_cmp_eq_u32 vcc_hi, s18
    s_cselect_b32 vcc_lo, vcc_lo, s18
    s_cmp_lg_u32 vcc_lo, s18
    s_addc_u32 s98, s98, 0
    s_waitcnt vmcnt(5)
    buffer_load_dwordx4 a[140:143], v1, s[32:35], s14 offen offset:128 nt
    s_waitcnt lgkmcnt(0)
    s_mov_b32 s96, s18
    s_mov_b32 s97, s18
    s_cmp_lg_u32 s99, 0
    s_cbranch_scc1 L_np3
    s_load_dword s96, s[60:61], 682240
    s_load_dword s7, s[60:61], 708864
    s_load_dword s7, s[60:61], 691456
    s_load_dword s97, s[60:61], 674048
L_np3:
    s_xor_b32 s14, s95, 147456
    s_waitcnt vmcnt(5)
    buffer_load_dwordx4 a[144:147], v1, s[32:35], s14 offen offset:0 nt
    s_waitcnt vmcnt(5)
    buffer_load_dwordx4 a[148:151], v1, s[32:35], s14 offen offset:128 nt
    s_mov_b64 vcc, s[96:97]
    s_cmp_eq_u32 vcc_hi, s18
    s_cselect_b32 vcc_lo, vcc_lo, s18
    s_cmp_lg_u32 vcc_lo, s18
    s_subb_u32 s98, s98, 0
    s_xor_b32 s14, s95, 151552
    s_waitcnt vmcnt(5)
    buffer_load_dwordx4 a[152:155], v1, s[32:35], s14 offen offset:0 nt
    s_mov_b64 vcc, s[96:97]
    s_cmp_eq_u32 vcc_hi, s18
    s_cselect_b32 vcc_lo, vcc_lo, s18
    s_cmp_lg_u32 vcc_lo, s18
    s_subb_u32 s98, s98, 0
    s_waitcnt vmcnt(5)
    buffer_load_dwordx4 a[156:159], v1, s[32:35], s14 offen offset:128 nt
    s_mov_b64 vcc, s[96:97]
    s_cmp_eq_u32 vcc_hi, s18
    s_cselect_b32 vcc_lo, vcc_lo, s18
    s_cmp_lg_u32 vcc_lo, s18
    s_subb_u32 s98, s98, 0
    s_xor_b32 s14, s95, 540672
    s_waitcnt vmcnt(5)
    buffer_load_dwordx4 a[160:163], v1, s[32:35], s14 offen offset:0 nt
    s_mov_b64 vcc, s[96:97]
    s_cmp_eq_u32 vcc_hi, s18
    s_cselect_b32 vcc_lo, vcc_lo, s18
    s_cmp_lg_u32 vcc_lo, s18
    s_subb_u32 s98, s98, 0
    s_waitcnt vmcnt(5)
    buffer_load_dwordx4 a[164:167], v1, s[32:35], s14 offen offset:128 nt
    s_mov_b64 vcc, s[96:97]
    s_cmp_eq_u32 vcc_hi, s18
    s_cselect_b32 vcc_lo, vcc_lo, s18
    s_cmp_lg_u32 vcc_lo, s18
    s_subb_u32 s98, s98, 0
    s_xor_b32 s14, s95, 544768
    s_waitcnt vmcnt(5)
    buffer_load_dwordx4 a[168:171], v1, s[32:35], s14 offen offset:0 nt
    s_waitcnt lgkmcnt(0)
    s_mov_b32 s96, s18
    s_mov_b32 s97, s18
    s_cmp_lg_u32 s99, 0
    s_cbranch_scc1 L_np4
    s_load_dword s96, s[60:61], 723968
    s_load_dword s7, s[60:61], 766976
    s_load_dword s7, s[60:61], 749568
    s_load_dword s97, s[60:61], 732160
L_np4:
    s_waitcnt vmcnt(5)
    buffer_load_dwordx4 a[172:175], v1, s[32:35], s14 offen offset:128 nt
    s_xor_b32 s14, s95, 671744
    s_waitcnt vmcnt(5)
    buffer_load_dwordx4 a[176:179], v1, s[32:35], s14 offen offset:0 nt
    s_mov_b64 vcc, s[96:97]
    s_cmp_eq_u32 vcc_hi, s18
    s_cselect_b32 vcc_lo, vcc_lo, s18
    s_cmp_lg_u32 vcc_lo, s18
    s_addc_u32 s98, s98, 0
    s_waitcnt vmcnt(5)
    buffer_load_dwordx4 a[180:183], v1, s[32:35], s14 offen offset:128 nt
    s_mov_b64 vcc, s[96:97]
    s_cmp_eq_u32 vcc_hi, s18
    s_cselect_b32 vcc_lo, vcc_lo, s18
    s_cmp_lg_u32 vcc_lo, s18
    s_addc_u32 s98, s98, 0
    s_xor_b32 s14, s95, 675840
    s_waitcnt vmcnt(5)
    buffer_load_dwordx4 a[184:187], v1, s[32:35], s14 offen offset:0 nt
    s_mov_b64 vcc, s[96:97]
    s_cmp_eq_u32 vcc_hi, s18
    s_cselect_b32 vcc_lo, vcc_lo, s18
    s_cmp_lg_u32 vcc_lo, s18
    s_addc_u32 s98, s98, 0
    s_waitcnt vmcnt(5)
    buffer_load_dwordx4 a[188:191], v1, s[32:35], s14 offen offset:128 nt
    s_mov_b64 vcc, s[96:97]
    s_cmp_eq_u32 vcc_hi, s18
    s_cselect_b32 vcc_lo, vcc_lo, s18
    s_cmp_lg_u32 vcc_lo, s18
    s_addc_u32 s98, s98, 0
    s_xor_b32 s14, s95, 278528
    s_waitcnt vmcnt(5)
    buffer_load_dwordx4 a[192:195], v1, s[32:35], s14 offen offset:0 nt
    s_mov_b64 vcc, s[96:97]
    s_cmp_eq_u32 vcc_hi, s18
    s_cselect_b32 vcc_lo, vcc_lo, s18
    s_cmp_lg_u32 vcc_lo, s18
    s_addc_u32 s98, s98, 0
    s_waitcnt vmcnt(5)
    buffer_load_dwordx4 a[196:199], v1, s[32:35], s14 offen offset:128 nt
    s_waitcnt lgkmcnt(0)
    s_mov_b32 s96, s18
    s_mov_b32 s97, s18
    s_cmp_lg_u32 s99, 0
    s_cbranch_scc1 L_np5
    s_load_dword s96, s[60:61], 782080
    s_load_dword s7, s[60:61], 808704
    s_load_dword s7, s[60:61], 791296
    s_load_dword s97, s[60:61], 773888
L_np5:
    s_xor_b32 s14, s95, 282624
    s_waitcnt vmcnt(5)
    buffer_load_dwordx4 a[200:203], v1, s[32:35], s14 offen offset:0 nt
    s_waitcnt vmcnt(5)
    buffer_load_dwordx4 a[204:207], v1, s[32:35], s14 offen offset:128 nt
    s_mov_b64 vcc, s[96:97]
    s_cmp_eq_u32 vcc_hi, s18
    s_cselect_b32 vcc_lo, vcc_lo, s18
    s_cmp_lg_u32 vcc_lo, s18
    s_subb_u32 s98, s98, 0
    s_xor_b32 s14, s95, 409600
    s_waitcnt vmcnt(5)
    buffer_load_dwordx4 a[208:211], v1, s[32:35], s14 offen offset:0 nt
    s_mov_b64 vcc, s[96:97]
    s_cmp_eq_u32 vcc_hi, s18
    s_cselect_b32 vcc_lo, vcc_lo, s18
    s_cmp_lg_u32 vcc_lo, s18
    s_subb_u32 s98, s98, 0
    s_waitcnt vmcnt(5)
    buffer_load_dwordx4 a[212:215], v1, s[32:35], s14 offen offset:128 nt
    s_mov_b64 vcc, s[96:97]
    s_cmp_eq_u32 vcc_hi, s18
    s_cselect_b32 vcc_lo, vcc_lo, s18
    s_cmp_lg_u32 vcc_lo, s18
    s_subb_u32 s98, s98, 0
    s_xor_b32 s14, s95, 413696
    s_waitcnt vmcnt(5)
    buffer_load_dwordx4 a[216:219], v1, s[32:35], s14 offen offset:0 nt
    s_mov_b64 vcc, s[96:97]
    s_cmp_eq_u32 vcc_hi, s18
    s_cselect_b32 vcc_lo, vcc_lo, s18
    s_cmp_lg_u32 vcc_lo, s18
    s_subb_u32 s98, s98, 0
    s_waitcnt vmcnt(5)
    buffer_load_dwordx4 a[220:223], v1, s[32:35], s14 offen offset:128 nt
    s_mov_b64 vcc, s[96:97]
    s_cmp_eq_u32 vcc_hi, s18
    s_cselect_b32 vcc_lo, vcc_lo, s18
    s_cmp_lg_u32 vcc_lo, s18
    s_subb_u32 s98, s98, 0
    s_xor_b32 s14, s95, 802816
    s_waitcnt vmcnt(5)
    buffer_load_dwordx4 a[224:227], v1, s[32:35], s14 offen offset:0 nt
    s_waitcnt lgkmcnt(0)
    s_mov_b32 s96, s18
    s_mov_b32 s97, s18
    s_cmp_lg_u32 s99, 0
    s_cbranch_scc1 L_np6
    s_load_dword s96, s[60:61], 823808
    s_load_dword s7, s[60:61], 866816
    s_load_dword s7, s[60:61], 849408
    s_load_dword s97, s[60:61], 832000
L_np6:
    s_waitcnt vmcnt(5)
    buffer_load_dwordx4 a[228:231], v1, s[32:35], s14 offen offset:128 nt
    s_xor_b32 s14, s95, 806912
    s_waitcnt vmcnt(5)
    buffer_load_dwordx4 a[232:235], v1, s[32:35], s14 offen offset:0 nt
    s_mov_b64 vcc, s[96:97]
    s_cmp_eq_u32 vcc_hi, s18
    s_cselect_b32 vcc_lo, vcc_lo, s18
    s_cmp_lg_u32 vcc_lo, s18
    s_addc_u32 s98, s98, 0
    s_waitcnt vmcnt(5)
    buffer_load_dwordx4 a[236:239], v1, s[32:35], s14 offen offset:128 nt
    s_mov_b64 vcc, s[96:97]
    s_cmp_eq_u32 vcc_hi, s18
    s_cselect_b32 vcc_lo, vcc_lo, s18
    s_cmp_lg_u32 vcc_lo, s18
    s_addc_u32 s98, s98, 0
    s_xor_b32 s14, s95, 933888
    s_waitcnt vmcnt(5)
    buffer_load_dwordx4 a[240:243], v1, s[32:35], s14 offen offset:0 nt
    s_mov_b64 vcc, s[96:97]
    s_cmp_eq_u32 vcc_hi, s18
    s_cselect_b32 vcc_lo, vcc_lo, s18
    s_cmp_lg_u32 vcc_lo, s18
    s_addc_u32 s98, s98, 0
    s_waitcnt vmcnt(5)
    buffer_load_dwordx4 a[244:247], v1, s[32:35], s14 offen offset:128 nt
    s_mov_b64 vcc, s[96:97]
    s_cmp_eq_u32 vcc_hi, s18
    s_cselect_b32 vcc_lo, vcc_lo, s18
    s_cmp_lg_u32 vcc_lo, s18
    s_addc_u32 s98, s98, 0
    s_xor_b32 s14, s95, 937984
    s_waitcnt vmcnt(5)
    buffer_load_dwordx4 a[248:251], v1, s[32:35], s14 offen offset:0 nt
    s_mov_b64 vcc, s[96:97]
    s_cmp_eq_u32 vcc_hi, s18
    s_cselect_b32 vcc_lo, vcc_lo, s18
    s_cmp_lg_u32 vcc_lo, s18
    s_addc_u32 s98, s98, 0
    s_waitcnt vmcnt(5)
    buffer_load_dwordx4 a[252:255], v1, s[32:35], s14 offen offset:128 nt
    s_waitcnt lgkmcnt(0)
    s_mov_b32 s96, s18
    s_mov_b32 s97, s18
    s_cmp_lg_u32 s99, 0
    s_cbranch_scc1 L_np7
    s_load_dword s96, s[60:61], 881920
    s_load_dword s7, s[60:61], 908544
    s_load_dword s7, s[60:61], 891136
    s_load_dword s97, s[60:61], 873728
L_np7:
    s_mov_b32 s4, 0
    s_waitcnt vmcnt(5)
    buffer_load_dwordx4 v[160:163], v15, s[56:59], s4 offen nt
    s_mov_b32 s4, 8192
    s_waitcnt vmcnt(5)
    buffer_load_dwordx4 v[164:167], v15, s[56:59], s4 offen nt
    s_mov_b64 vcc, s[96:97]
    s_cmp_eq_u32 vcc_hi, s18
    s_cselect_b32 vcc_lo, vcc_lo, s18
    s_cmp_lg_u32 vcc_lo, s18
    s_subb_u32 s98, s98, 0
    s_mov_b32 s4, 16384
    s_waitcnt vmcnt(5)
    buffer_load_dwordx4 v[168:171], v15, s[56:59], s4 offen nt
    s_mov_b64 vcc, s[96:97]
    s_cmp_eq_u32 vcc_hi, s18
    s_cselect_b32 vcc_lo, vcc_lo, s18
    s_cmp_lg_u32 vcc_lo, s18
    s_subb_u32 s98, s98, 0
    s_mov_b32 s4, 24576
    s_waitcnt vmcnt(5)
    buffer_load_dwordx4 v[172:175], v15, s[56:59], s4 offen nt
    s_mov_b64 vcc, s[96:97]
    s_cmp_eq_u32 vcc_hi, s18
    s_cselect_b32 vcc_lo, vcc_lo, s18
    s_cmp_lg_u32 vcc_lo, s18
    s_subb_u32 s98, s98, 0
    s_waitcnt vmcnt(5)
    buffer_load_dwordx4 v[192:195], v1, s[36:39], s100 offen offset:0 nt
    s_mov_b64 vcc, s[96:97]
    s_cmp_eq_u32 vcc_hi, s18
    s_cselect_b32 vcc_lo, vcc_lo, s18
    s_cmp_lg_u32 vcc_lo, s18
    s_subb_u32 s98, s98, 0
    s_waitcnt vmcnt(5)
    buffer_load_dwordx4 v[196:199], v1, s[36:39], s100 offen offset:128 nt
    s_mov_b64 vcc, s[96:97]
    s_cmp_eq_u32 vcc_hi, s18
    s_cselect_b32 vcc_lo, vcc_lo, s18
    s_cmp_lg_u32 vcc_lo, s18
    s_subb_u32 s98, s98, 0
    buffer_load_dwordx4 v[128:131], v11, s[60:63], s6 offen offset:0
    buffer_load_dwordx4 v[132:135], v11, s[60:63], s6 offen offset:512
    buffer_load_dwordx4 v[136:139], v11, s[60:63], s6 offen offset:1024
    buffer_load_dwordx4 v[140:143], v11, s[60:63], s6 offen offset:1536
    s_xor_b32 s14, s100, 4096
    s_waitcnt vmcnt(9)
    buffer_load_dwordx4 v[200:203], v1, s[36:39], s14 offen offset:0 nt
    s_cmp_eq_u32 s99, 0
    s_cbranch_scc1 L_decide
L_decided:
    s_waitcnt vmcnt(9)
    buffer_load_dwordx4 v[204:207], v1, s[36:39], s14 offen offset:128 nt
    s_xor_b32 s14, s100, 131072
    s_waitcnt vmcnt(9)
    buffer_load_dwordx4 v[208:211], v1, s[36:39], s14 offen offset:0 nt
    s_waitcnt vmcnt(9)
    buffer_load_dwordx4 v[212:215], v1, s[36:39], s14 offen offset:128 nt
    v_perm_b32 v96, v164, v160, s16
    v_perm_b32 v97, v172, v168, s16
    ds_write_b64 v14, v[96:97] offset:23296
    v_perm_b32 v98, v164, v160, s17
    v_perm_b32 v99, v172, v168, s17
    ds_write_b64 v14, v[98:99] offset:23936
    v_perm_b32 v100, v165, v161, s16
    v_perm_b32 v101, v173, v169, s16
    ds_write_b64 v14, v[100:101] offset:24576
    v_perm_b32 v102, v165, v161, s17
    v_perm_b32 v103, v173, v169, s17
    ds_write_b64 v14, v[102:103] offset:25216
    v_perm_b32 v104, v166, v162, s16
    v_perm_b32 v105, v174, v170, s16
    ds_write_b64 v14, v[104:105] offset:25856
    v_perm_b32 v106, v166, v162, s17
    v_perm_b32 v107, v174, v170, s17
    ds_write_b64 v14, v[106:107] offset:26496
    v_perm_b32 v108, v167, v163, s16
    v_perm_b32 v109, v175, v171, s16
    ds_write_b64 v14, v[108:109] offset:27136
    v_perm_b32 v110, v167, v163, s17
    v_perm_b32 v111, v175, v171, s17
    ds_write_b64 v14, v[110:111] offset:27776
    s_xor_b32 s14, s100, 135168
    s_waitcnt vmcnt(9)
    buffer_load_dwordx4 v[216:219], v1, s[36:39], s14 offen offset:0 nt
    s_waitcnt vmcnt(9)
    buffer_load_dwordx4 v[220:223], v1, s[36:39], s14 offen offset:128 nt
    s_xor_b32 s14, s100, 16384
    s_waitcnt vmcnt(5)
    buffer_load_dwordx4 v[224:227], v1, s[36:39], s14 offen offset:0 nt
L_chk_q:
    v_bitop3_b32 v32, v128, v132, s18 bitop3:0x7e
    v_bitop3_b32 v33, v129, v133, s19 bitop3:0x7e
    v_bitop3_b32 v34, v130, v134, s20 bitop3:0x7e
    v_or3_b32 v32, v32, v33, v34
    v_bitop3_b32 v33, v131, v135, s21 bitop3:0x7e
    v_bitop3_b32 v34, v136, v140, s18 bitop3:0x7e
    v_or3_b32 v32, v32, v33, v34
    v_bitop3_b32 v33, v137, v141, s19 bitop3:0x7e
    v_bitop3_b32 v34, v138, v142, s20 bitop3:0x7e
    v_or3_b32 v32, v32, v33, v34
    v_bitop3_b32 v33, v139, v143, s21 bitop3:0x7e
    v_bitop3_b32 v32, v32, v33, s93 bitop3:0x54
    v_cmp_ne_u32 vcc, 0, v32
    s_nop 0
    s_cbranch_vccnz L_retry_q
L_ok_q:
    v_and_b32 v128, s93, v128
    v_and_b32 v129, s93, v129
    v_and_b32 v130, s93, v130
    v_and_b32 v131, s93, v131
    v_and_b32 v132, s93, v132
    v_and_b32 v133, s93, v133
    v_and_b32 v134, s93, v134
    v_and_b32 v135, s93, v135
    s_waitcnt vmcnt(5)
    buffer_load_dwordx4 v[228:231], v1, s[36:39], s14 offen offset:128 nt
    v_and_b32 v136, s93, v136
    v_and_b32 v137, s93, v137
    v_and_b32 v138, s93, v138
    v_and_b32 v139, s93, v139
    v_and_b32 v140, s93, v140
    v_and_b32 v141, s93, v141
    v_and_b32 v142, s93, v142
    v_and_b32 v143, s93, v143
    v_pk_add_f32 v[32:33], v[128:129], v[132:133]
    v_pk_add_f32 v[34:35], v[130:131], v[134:135]
    v_pk_add_f32 v[36:37], v[136:137], v[140:141]
    v_pk_add_f32 v[38:39], v[138:139], v[142:143]
    v_pk_add_f32 v[32:33], v[32:33], v[36:37]
    v_pk_add_f32 v[34:35], v[34:35], v[38:39]
    v_cvt_pk_bf16_f32 v36, v32, v33
    v_cvt_pk_bf16_f32 v37, v34, v35
    v_mov_b32 v38, s101
    s_lshl_b32 s8, s3, 2
    v_mov_b32 v39, s8
    v_mov_b32 v44, 0
    ds_write_b16 v10, v36 offset:18688
    ds_write_b16_d16_hi v10, v36 offset:18704
    ds_write_b16 v10, v37 offset:18720
    ds_write_b16_d16_hi v10, v37 offset:18736
    ds_write_b32 v39, v38 offset:18560
    s_waitcnt lgkmcnt(0)
    s_barrier
    ds_read_b128 v[16:19], v7 offset:18688
    ds_read_b128 v[20:23], v7 offset:18816
    ds_read_b128 v[24:27], v7 offset:19712
    ds_read_b128 v[28:31], v7 offset:19840
    ds_read_b128 v[40:43], v44 offset:18560
    s_xor_b32 s14, s100, 20480
    s_waitcnt vmcnt(5)
    buffer_load_dwordx4 v[232:235], v1, s[36:39], s14 offen offset:0 nt
    s_waitcnt lgkmcnt(0)
    v_or3_b32 v40, v40, v41, v42
    v_or_b32 v40, v40, v43
    s_nop 0
    v_readfirstlane_b32 s101, v40
    s_nop 0
    s_cmp_eq_u32 s101, 0
    s_cselect_b32 s31, s6, 0
    s_add_u32 s31, s31, 1048576
    s_add_u32 s6, s31, 0x80000
    s_cmp_eq_u32 s101, 0
    s_cselect_b32 s6, s6, 0
    s_lshl_b32 s7, s9, 8
    s_lshl4_add_u32 s7, s12, s7
    s_add_u32 s7, s7, 1097728
    s_lshl2_add_u32 s8, s11, s7
    s_mov_b64 exec, 1
    buffer_store_dword v3, off, s[60:63], s8
    s_mov_b64 exec, -1
    s_lshl2_add_u32 s96, s9, s3
    s_lshl_b32 s96, s96, 8
    s_add_u32 s96, s96, 1081344
    s_lshr_b32 s97, s2, 3
    s_add_u32 s97, s97, s96
    s_mov_b32 s99, 28
    s_mov_b64 vcc, 0
    s_waitcnt vmcnt(6)
    buffer_load_dwordx4 v[236:239], v1, s[36:39], s14 offen offset:128 nt
    v_mfma_f32_16x16x32_bf16 v[32:35], a[0:3], v[24:27], 0
    v_mfma_f32_16x16x32_bf16 v[32:35], a[4:7], v[28:31], v[32:35]
    v_mfma_f32_16x16x32_bf16 v[36:39], a[8:11], v[24:27], 0
    v_mfma_f32_16x16x32_bf16 v[36:39], a[12:15], v[28:31], v[36:39]
    v_mfma_f32_16x16x32_bf16 v[40:43], a[16:19], v[24:27], 0
    v_mfma_f32_16x16x32_bf16 v[40:43], a[20:23], v[28:31], v[40:43]
    v_mfma_f32_16x16x32_bf16 v[44:47], a[24:27], v[24:27], 0
    v_mfma_f32_16x16x32_bf16 v[44:47], a[28:31], v[28:31], v[44:47]
    s_nop 1
    v_add_f32_dpp v64, v33, v32 row_shl:4 row_mask:0xf bank_mask:0xf bound_ctrl:0
    v_add_f32_dpp v65, v35, v34 row_shl:4 row_mask:0xf bank_mask:0xf bound_ctrl:0
    v_add_f32_dpp v66, v37, v36 row_shl:4 row_mask:0xf bank_mask:0xf bound_ctrl:0
    v_add_f32_dpp v67, v39, v38 row_shl:4 row_mask:0xf bank_mask:0xf bound_ctrl:0
    v_add_f32_dpp v68, v41, v40 row_shl:4 row_mask:0xf bank_mask:0xf bound_ctrl:0
    v_add_f32_dpp v69, v43, v42 row_shl:4 row_mask:0xf bank_mask:0xf bound_ctrl:0
    v_add_f32_dpp v70, v45, v44 row_shl:4 row_mask:0xf bank_mask:0xf bound_ctrl:0
    v_add_f32_dpp v71, v47, v46 row_shl:4 row_mask:0xf bank_mask:0xf bound_ctrl:0
    v_max_f32 v5, v64, v65
    v_max3_f32 v5, v66, v67, v5
    v_max3_f32 v5, v68, v69, v5
    v_max3_f32 v5, v70, v71, v5
    v_mfma_f32_16x16x32_bf16 v[32:35], a[32:35], v[24:27], 0
    v_mfma_f32_16x16x32_bf16 v[32:35], a[36:39], v[28:31], v[32:35]
    v_mfma_f32_16x16x32_bf16 v[36:39], a[40:43], v[24:27], 0
    v_mfma_f32_16x16x32_bf16 v[36:39], a[44:47], v[28:31], v[36:39]
    s_xor_b32 s14, s100, 147456
    s_waitcnt vmcnt(6)
    buffer_load_dwordx4 v[240:243], v1, s[36:39], s14 offen offset:0 nt
    v_mfma_f32_16x16x32_bf16 v[40:43], a[48:51], v[24:27], 0
    v_mfma_f32_16x16x32_bf16 v[40:43], a[52:55], v[28:31], v[40:43]
    v_mfma_f32_16x16x32_bf16 v[44:47], a[56:59], v[24:27], 0
    v_mfma_f32_16x16x32_bf16 v[44:47], a[60:63], v[28:31], v[44:47]
    v_add_f32_dpp v72, v33, v32 row_shl:4 row_mask:0xf bank_mask:0xf bound_ctrl:0
    v_add_f32_dpp v73, v35, v34 row_shl:4 row_mask:0xf bank_mask:0xf bound_ctrl:0
    v_add_f32_dpp v74, v37, v36 row_shl:4 row_mask:0xf bank_mask:0xf bound_ctrl:0
    v_add_f32_dpp v75, v39, v38 row_shl:4 row_mask:0xf bank_mask:0xf bound_ctrl:0
    s_nop 1
    v_add_f32_dpp v76, v41, v40 row_shl:4 row_mask:0xf bank_mask:0xf bound_ctrl:0
    v_add_f32_dpp v77, v43, v42 row_shl:4 row_mask:0xf bank_mask:0xf bound_ctrl:0
    v_add_f32_dpp v78, v45, v44 row_shl:4 row_mask:0xf bank_mask:0xf bound_ctrl:0
    v_add_f32_dpp v79, v47, v46 row_shl:4 row_mask:0xf bank_mask:0xf bound_ctrl:0
    v_max3_f32 v5, v72, v73, v5
    v_max3_f32 v5, v74, v75, v5
    v_max3_f32 v5, v76, v77, v5
    v_max3_f32 v5, v78, v79, v5
    v_mfma_f32_16x16x32_bf16 v[32:35], a[64:67], v[24:27], 0
    v_mfma_f32_16x16x32_bf16 v[32:35], a[68:71], v[28:31], v[32:35]
    v_mfma_f32_16x16x32_bf16 v[36:39], a[72:75], v[24:27], 0
    v_mfma_f32_16x16x32_bf16 v[36:39], a[76:79], v[28:31], v[36:39]
    v_mfma_f32_16x16x32_bf16 v[40:43], a[80:83], v[24:27], 0
    v_mfma_f32_16x16x32_bf16 v[40:43], a[84:87], v[28:31], v[40:43]
    v_mfma_f32_16x16x32_bf16 v[44:47], a[88:91], v[24:27], 0
    v_mfma_f32_16x16x32_bf16 v[44:47], a[92:95], v[28:31], v[44:47]
    s_waitcnt vmcnt(6)
    buffer_load_dwordx4 v[244:247], v1, s[36:39], s14 offen offset:128 nt
    v_add_f32_dpp v80, v33, v32 row_shl:4 row_mask:0xf bank_mask:0xf bound_ctrl:0
    v_add_f32_dpp v81, v35, v34 row_shl:4 row_mask:0xf bank_mask:0xf bound_ctrl:0
    v_add_f32_dpp v82, v37, v36 row_shl:4 row_mask:0xf bank_mask:0xf bound_ctrl:0
    v_add_f32_dpp v83, v39, v38 row_shl:4 row_mask:0xf bank_mask:0xf bound_ctrl:0
    v_add_f32_dpp v84, v41, v40 row_shl:4 row_mask:0xf bank_mask:0xf bound_ctrl:0
    v_add_f32_dpp v85, v43, v42 row_shl:4 row_mask:0xf bank_mask:0xf bound_ctrl:0
    v_add_f32_dpp v86, v45, v44 row_shl:4 row_mask:0xf bank_mask:0xf bound_ctrl:0
    v_add_f32_dpp v87, v47, v46 row_shl:4 row_mask:0xf bank_mask:0xf bound_ctrl:0
    v_max3_f32 v5, v80, v81, v5
    v_max3_f32 v5, v82, v83, v5
    v_max3_f32 v5, v84, v85, v5
    v_max3_f32 v5, v86, v87, v5
    v_mfma_f32_16x16x32_bf16 v[32:35], a[96:99], v[24:27], 0
    v_mfma_f32_16x16x32_bf16 v[32:35], a[100:103], v[28:31], v[32:35]
    v_mfma_f32_16x16x32_bf16 v[36:39], a[104:107], v[24:27], 0
    v_mfma_f32_16x16x32_bf16 v[36:39], a[108:111], v[28:31], v[36:39]
    v_mfma_f32_16x16x32_bf16 v[40:43], a[112:115], v[24:27], 0
    v_mfma_f32_16x16x32_bf16 v[40:43], a[116:119], v[28:31], v[40:43]
    v_mfma_f32_16x16x32_bf16 v[44:47], a[120:123], v[24:27], 0
    v_mfma_f32_16x16x32_bf16 v[44:47], a[124:127], v[28:31], v[44:47]
    s_nop 1
    v_add_f32_dpp v88, v33, v32 row_shl:4 row_mask:0xf bank_mask:0xf bound_ctrl:0
    v_add_f32_dpp v89, v35, v34 row_shl:4 row_mask:0xf bank_mask:0xf bound_ctrl:0
    v_add_f32_dpp v90, v37, v36 row_shl:4 row_mask:0xf bank_mask:0xf bound_ctrl:0
    v_add_f32_dpp v91, v39, v38 row_shl:4 row_mask:0xf bank_mask:0xf bound_ctrl:0
    s_xor_b32 s14, s100, 151552
    s_waitcnt vmcnt(6)
    buffer_load_dwordx4 v[248:251], v1, s[36:39], s14 offen offset:0 nt
    v_add_f32_dpp v92, v41, v40 row_shl:4 row_mask:0xf bank_mask:0xf bound_ctrl:0
    v_add_f32_dpp v93, v43, v42 row_shl:4 row_mask:0xf bank_mask:0xf bound_ctrl:0
    v_add_f32_dpp v94, v45, v44 row_shl:4 row_mask:0xf bank_mask:0xf bound_ctrl:0
    v_add_f32_dpp v95, v47, v46 row_shl:4 row_mask:0xf bank_mask:0xf bound_ctrl:0
    v_max3_f32 v5, v88, v89, v5
    v_max3_f32 v5, v90, v91, v5
    v_max3_f32 v5, v92, v93, v5
    v_max3_f32 v5, v94, v95, v5
    v_mfma_f32_16x16x32_bf16 v[32:35], a[128:131], v[24:27], 0
    v_mfma_f32_16x16x32_bf16 v[32:35], a[132:135], v[28:31], v[32:35]
    v_mfma_f32_16x16x32_bf16 v[36:39], a[136:139], v[24:27], 0
    v_mfma_f32_16x16x32_bf16 v[36:39], a[140:143], v[28:31], v[36:39]
    v_mfma_f32_16x16x32_bf16 v[40:43], a[144:147], v[24:27], 0
    v_mfma_f32_16x16x32_bf16 v[40:43], a[148:151], v[28:31], v[40:43]
    v_mfma_f32_16x16x32_bf16 v[44:47], a[152:155], v[24:27], 0
    v_mfma_f32_16x16x32_bf16 v[44:47], a[156:159], v[28:31], v[44:47]
    s_nop 1
    v_add_f32_dpp v96, v33, v32 row_shl:4 row_mask:0xf bank_mask:0xf bound_ctrl:0
    v_add_f32_dpp v97, v35, v34 row_shl:4 row_mask:0xf bank_mask:0xf bound_ctrl:0
    v_add_f32_dpp v98, v37, v36 row_shl:4 row_mask:0xf bank_mask:0xf bound_ctrl:0
    v_add_f32_dpp v99, v39, v38 row_shl:4 row_mask:0xf bank_mask:0xf bound_ctrl:0
    v_add_f32_dpp v100, v41, v40 row_shl:4 row_mask:0xf bank_mask:0xf bound_ctrl:0
    v_add_f32_dpp v101, v43, v42 row_shl:4 row_mask:0xf bank_mask:0xf bound_ctrl:0
    v_add_f32_dpp v102, v45, v44 row_shl:4 row_mask:0xf bank_mask:0xf bound_ctrl:0
    v_add_f32_dpp v103, v47, v46 row_shl:4 row_mask:0xf bank_mask:0xf bound_ctrl:0
    s_waitcnt vmcnt(6)
    buffer_load_dwordx4 v[252:255], v1, s[36:39], s14 offen offset:128 nt
    v_max3_f32 v5, v96, v97, v5
    v_max3_f32 v5, v98, v99, v5
    v_max3_f32 v5, v100, v101, v5
    v_max3_f32 v5, v102, v103, v5
    v_mfma_f32_16x16x32_bf16 v[32:35], a[160:163], v[24:27], 0
    v_mfma_f32_16x16x32_bf16 v[32:35], a[164:167], v[28:31], v[32:35]
    v_mfma_f32_16x16x32_bf16 v[36:39], a[168:171], v[24:27], 0
    v_mfma_f32_16x16x32_bf16 v[36:39], a[172:175], v[28:31], v[36:39]
    v_mfma_f32_16x16x32_bf16 v[40:43], a[176:179], v[24:27], 0
    v_mfma_f32_16x16x32_bf16 v[40:43], a[180:183], v[28:31], v[40:43]
    v_mfma_f32_16x16x32_bf16 v[44:47], a[184:187], v[24:27], 0
    v_mfma_f32_16x16x32_bf16 v[44:47], a[188:191], v[28:31], v[44:47]
    s_nop 1
    v_add_f32_dpp v104, v33, v32 row_shl:4 row_mask:0xf bank_mask:0xf bound_ctrl:0
    v_add_f32_dpp v105, v35, v34 row_shl:4 row_mask:0xf bank_mask:0xf bound_ctrl:0
    v_add_f32_dpp v106, v37, v36 row_shl:4 row_mask:0xf bank_mask:0xf bound_ctrl:0
    v_add_f32_dpp v107, v39, v38 row_shl:4 row_mask:0xf bank_mask:0xf bound_ctrl:0
    v_add_f32_dpp v108, v41, v40 row_shl:4 row_mask:0xf bank_mask:0xf bound_ctrl:0
    v_add_f32_dpp v109, v43, v42 row_shl:4 row_mask:0xf bank_mask:0xf bound_ctrl:0
    v_add_f32_dpp v110, v45, v44 row_shl:4 row_mask:0xf bank_mask:0xf bound_ctrl:0
    v_add_f32_dpp v111, v47, v46 row_shl:4 row_mask:0xf bank_mask:0xf bound_ctrl:0
    v_max3_f32 v5, v104, v105, v5
    v_max3_f32 v5, v106, v107, v5
    v_max3_f32 v5, v108, v109, v5
    v_max3_f32 v5, v110, v111, v5
    s_waitcnt vmcnt(6)
    buffer_load_dwordx4 v[128:131], v2, s[40:43], s100 offen offset:0 nt
    v_mfma_f32_16x16x32_bf16 v[32:35], a[192:195], v[24:27], 0
    v_mfma_f32_16x16x32_bf16 v[32:35], a[196:199], v[28:31], v[32:35]
    v_mfma_f32_16x16x32_bf16 v[36:39], a[200:203], v[24:27], 0
    v_mfma_f32_16x16x32_bf16 v[36:39], a[204:207], v[28:31], v[36:39]
    v_mfma_f32_16x16x32_bf16 v[40:43], a[208:211], v[24:27], 0
    v_mfma_f32_16x16x32_bf16 v[40:43], a[212:215], v[28:31], v[40:43]
    v_mfma_f32_16x16x32_bf16 v[44:47], a[216:219], v[24:27], 0
    v_mfma_f32_16x16x32_bf16 v[44:47], a[220:223], v[28:31], v[44:47]
    s_nop 1
    v_add_f32_dpp v112, v33, v32 row_shl:4 row_mask:0xf bank_mask:0xf bound_ctrl:0
    v_add_f32_dpp v113, v35, v34 row_shl:4 row_mask:0xf bank_mask:0xf bound_ctrl:0
    v_add_f32_dpp v114, v37, v36 row_shl:4 row_mask:0xf bank_mask:0xf bound_ctrl:0
    v_add_f32_dpp v115, v39, v38 row_shl:4 row_mask:0xf bank_mask:0xf bound_ctrl:0
    v_add_f32_dpp v116, v41, v40 row_shl:4 row_mask:0xf bank_mask:0xf bound_ctrl:0
    v_add_f32_dpp v117, v43, v42 row_shl:4 row_mask:0xf bank_mask:0xf bound_ctrl:0
    v_add_f32_dpp v118, v45, v44 row_shl:4 row_mask:0xf bank_mask:0xf bound_ctrl:0
    v_add_f32_dpp v119, v47, v46 row_shl:4 row_mask:0xf bank_mask:0xf bound_ctrl:0
    v_max3_f32 v5, v112, v113, v5
    v_max3_f32 v5, v114, v115, v5
    v_max3_f32 v5, v116, v117, v5
    v_max3_f32 v5, v118, v119, v5
    v_mfma_f32_16x16x32_bf16 v[32:35], a[224:227], v[24:27], 0
    v_mfma_f32_16x16x32_bf16 v[32:35], a[228:231], v[28:31], v[32:35]
    v_mfma_f32_16x16x32_bf16 v[36:39], a[232:235], v[24:27], 0
    v_mfma_f32_16x16x32_bf16 v[36:39], a[236:239], v[28:31], v[36:39]
    s_waitcnt vmcnt(5)
    buffer_load_dwordx4 v[132:135], v2, s[40:43], s100 offen offset:2048 nt
    v_mfma_f32_16x16x32_bf16 v[40:43], a[240:243], v[24:27], 0
    v_mfma_f32_16x16x32_bf16 v[40:43], a[244:247], v[28:31], v[40:43]
    v_mfma_f32_16x16x32_bf16 v[44:47], a[248:251], v[24:27], 0
    v_mfma_f32_16x16x32_bf16 v[44:47], a[252:255], v[28:31], v[44:47]
    v_add_f32_dpp v120, v33, v32 row_shl:4 row_mask:0xf bank_mask:0xf bound_ctrl:0
    v_add_f32_dpp v121, v35, v34 row_shl:4 row_mask:0xf bank_mask:0xf bound_ctrl:0
    v_add_f32_dpp v122, v37, v36 row_shl:4 row_mask:0xf bank_mask:0xf bound_ctrl:0
    v_add_f32_dpp v123, v39, v38 row_shl:4 row_mask:0xf bank_mask:0xf bound_ctrl:0
    s_nop 1
    v_add_f32_dpp v124, v41, v40 row_shl:4 row_mask:0xf bank_mask:0xf bound_ctrl:0
    v_add_f32_dpp v125, v43, v42 row_shl:4 row_mask:0xf bank_mask:0xf bound_ctrl:0
    v_add_f32_dpp v126, v45, v44 row_shl:4 row_mask:0xf bank_mask:0xf bound_ctrl:0
    v_add_f32_dpp v127, v47, v46 row_shl:4 row_mask:0xf bank_mask:0xf bound_ctrl:0
    v_max3_f32 v5, v120, v121, v5
    v_max3_f32 v5, v122, v123, v5
    v_max3_f32 v5, v124, v125, v5
    v_max3_f32 v5, v126, v127, v5
    v_mfma_f32_16x16x32_bf16 v[32:35], v[192:195], v[16:19], 0
    v_mfma_f32_16x16x32_bf16 v[32:35], v[196:199], v[20:23], v[32:35]
    v_mfma_f32_16x16x32_bf16 v[36:39], v[200:203], v[16:19], 0
    v_mfma_f32_16x16x32_bf16 v[36:39], v[204:207], v[20:23], v[36:39]
    v_mfma_f32_16x16x32_bf16 v[40:43], v[208:211], v[16:19], 0
    v_mfma_f32_16x16x32_bf16 v[40:43], v[212:215], v[20:23], v[40:43]
    v_mfma_f32_16x16x32_bf16 v[44:47], v[216:219], v[16:19], 0
    v_mfma_f32_16x16x32_bf16 v[44:47], v[220:223], v[20:23], v[44:47]
    s_xor_b32 s14, s100, 4096
    s_waitcnt vmcnt(5)
    buffer_load_dwordx4 v[136:139], v2, s[40:43], s14 offen offset:0 nt
    v_add_f32_dpp v48, v33, v32 row_shl:4 row_mask:0xf bank_mask:0xf bound_ctrl:0
    v_add_f32_dpp v49, v35, v34 row_shl:4 row_mask:0xf bank_mask:0xf bound_ctrl:0
    v_add_f32_dpp v50, v37, v36 row_shl:4 row_mask:0xf bank_mask:0xf bound_ctrl:0
    v_add_f32_dpp v51, v39, v38 row_shl:4 row_mask:0xf bank_mask:0xf bound_ctrl:0
    v_add_f32_dpp v52, v41, v40 row_shl:4 row_mask:0xf bank_mask:0xf bound_ctrl:0
    v_add_f32_dpp v53, v43, v42 row_shl:4 row_mask:0xf bank_mask:0xf bound_ctrl:0
    v_add_f32_dpp v54, v45, v44 row_shl:4 row_mask:0xf bank_mask:0xf bound_ctrl:0
    v_add_f32_dpp v55, v47, v46 row_shl:4 row_mask:0xf bank_mask:0xf bound_ctrl:0
    v_max_f32 v4, v48, v49
    v_max3_f32 v4, v50, v51, v4
    v_max3_f32 v4, v52, v53, v4
    v_max3_f32 v4, v54, v55, v4
    v_mfma_f32_16x16x32_bf16 v[32:35], v[224:227], v[16:19], 0
    v_mfma_f32_16x16x32_bf16 v[32:35], v[228:231], v[20:23], v[32:35]
    v_mfma_f32_16x16x32_bf16 v[36:39], v[232:235], v[16:19], 0
    v_mfma_f32_16x16x32_bf16 v[36:39], v[236:239], v[20:23], v[36:39]
    v_mfma_f32_16x16x32_bf16 v[40:43], v[240:243], v[16:19], 0
    s_waitcnt vmcnt(5)
    buffer_load_dwordx4 v[140:143], v2, s[40:43], s14 offen offset:2048 nt
    v_mfma_f32_16x16x32_bf16 v[40:43], v[244:247], v[20:23], v[40:43]
    s_xor_b32 s14, s100, 131072
    s_waitcnt vmcnt(5)
    buffer_load_dwordx4 v[144:147], v2, s[40:43], s14 offen offset:0 nt
    v_mfma_f32_16x16x32_bf16 v[44:47], v[248:251], v[16:19], 0
    s_waitcnt vmcnt(5)
    buffer_load_dwordx4 v[148:151], v2, s[40:43], s14 offen offset:2048 nt
    v_mfma_f32_16x16x32_bf16 v[44:47], v[252:255], v[20:23], v[44:47]
    v_add_f32_dpp v56, v33, v32 row_shl:4 row_mask:0xf bank_mask:0xf bound_ctrl:0
    v_add_f32_dpp v57, v35, v34 row_shl:4 row_mask:0xf bank_mask:0xf bound_ctrl:0
    v_add_f32_dpp v58, v37, v36 row_shl:4 row_mask:0xf bank_mask:0xf bound_ctrl:0
    v_add_f32_dpp v59, v39, v38 row_shl:4 row_mask:0xf bank_mask:0xf bound_ctrl:0
    v_add_f32_dpp v60, v41, v40 row_shl:4 row_mask:0xf bank_mask:0xf bound_ctrl:0
    v_add_f32_dpp v61, v43, v42 row_shl:4 row_mask:0xf bank_mask:0xf bound_ctrl:0
    s_nop 1
    v_add_f32_dpp v62, v45, v44 row_shl:4 row_mask:0xf bank_mask:0xf bound_ctrl:0
    v_add_f32_dpp v63, v47, v46 row_shl:4 row_mask:0xf bank_mask:0xf bound_ctrl:0
    v_max3_f32 v4, v56, v57, v4
    v_max3_f32 v4, v58, v59, v4
    v_max3_f32 v4, v60, v61, v4
    v_max3_f32 v4, v62, v63, v4
    v_mov_b32 v7, v4
    v_mov_b32 v10, v5
    s_nop 0
    v_permlane16_swap_b32 v7, v4
    v_permlane16_swap_b32 v10, v5
    v_max_f32 v4, v4, v7
    v_max_f32 v5, v5, v10
    v_mov_b32 v7, v4
    v_mov_b32 v10, v5
    s_nop 0
    v_permlane32_swap_b32 v7, v4
    v_permlane32_swap_b32 v10, v5
    v_max_f32 v4, v4, v7
    s_xor_b32 s14, s100, 135168
    s_waitcnt vmcnt(5)
    buffer_load_dwordx4 v[152:155], v2, s[40:43], s14 offen offset:0 nt
    v_max_f32 v5, v5, v10
    v_and_b32 v11, 3, v0
    v_lshlrev_b32 v11, 4, v11
    v_add_u32 v11, 18432, v11
    s_lshl_b32 s8, s3, 2
    v_add_u32 v7, s8, v11
    s_mov_b64 exec, 15
    ds_write2_b32 v7, v4, v5 offset0:0 offset1:16
    s_mov_b64 exec, -1
    s_waitcnt lgkmcnt(0)
    s_barrier
    ds_read_b128 v[32:35], v11
    ds_read_b128 v[36:39], v11 offset:64
    v_mov_b32 v40, 0x3f803f80
    v_mov_b32 v41, 0x3f803f80
    v_mov_b32 v42, 0x3f803f80
    v_mov_b32 v43, 0x3f803f80
    s_waitcnt lgkmcnt(0)
    v_max3_f32 v4, v32, v33, v34
    v_max_f32 v4, v4, v35
    v_mul_f32 v4, s26, v4
    v_max3_f32 v5, v36, v37, v38
    v_max_f32 v5, v5, v39
    v_mul_f32 v5, s26, v5
    s_waitcnt vmcnt(5)
    buffer_load_dwordx4 v[156:159], v2, s[40:43], s14 offen offset:2048 nt
    v_mov_b32 v1, 8
    s_mov_b64 exec, 1
    buffer_store_byte v1, off, s[60:63], s97
    s_mov_b64 exec, -1
    buffer_load_ubyte v1, v0, s[60:63], s96 offen nt
    v_fma_f32 v48, v48, s26, -v4
    v_fma_f32 v49, v49, s26, -v4
    v_fma_f32 v50, v50, s26, -v4
    v_fma_f32 v51, v51, s26, -v4
    v_fma_f32 v52, v52, s26, -v4
    v_fma_f32 v53, v53, s26, -v4
    v_fma_f32 v54, v54, s26, -v4
    v_fma_f32 v55, v55, s26, -v4
    v_exp_f32 v48, v48
    v_exp_f32 v49, v49
    v_exp_f32 v50, v50
    v_exp_f32 v51, v51
    v_exp_f32 v52, v52
    v_exp_f32 v53, v53
    v_exp_f32 v54, v54
    v_exp_f32 v55, v55
    v_cvt_pk_bf16_f32 v48, v48, v49
    v_cvt_pk_bf16_f32 v49, v50, v51
    v_cvt_pk_bf16_f32 v50, v52, v53
    v_cvt_pk_bf16_f32 v51, v54, v55
    v_fma_f32 v56, v56, s26, -v4
    v_fma_f32 v57, v57, s26, -v4
    v_fma_f32 v58, v58, s26, -v4
    v_fma_f32 v59, v59, s26, -v4
    s_xor_b32 s14, s100, 16384
    s_waitcnt vmcnt(7)
    buffer_load_dwordx4 v[160:163], v2, s[40:43], s14 offen offset:0 nt
    v_fma_f32 v60, v60, s26, -v4
    v_fma_f32 v61, v61, s26, -v4
    v_fma_f32 v62, v62, s26, -v4
    v_fma_f32 v63, v63, s26, -v4
    v_exp_f32 v56, v56
    v_exp_f32 v57, v57
    v_exp_f32 v58, v58
    v_exp_f32 v59, v59
    v_exp_f32 v60, v60
    v_exp_f32 v61, v61
    v_exp_f32 v62, v62
    v_exp_f32 v63, v63
    v_cvt_pk_bf16_f32 v52, v56, v57
    v_cvt_pk_bf16_f32 v53, v58, v59
    v_cvt_pk_bf16_f32 v54, v60, v61
    v_cvt_pk_bf16_f32 v55, v62, v63
    v_mfma_f32_16x16x32_bf16 v[56:59], v[40:43], v[48:51], 0
    s_nop 0
    v_mfma_f32_16x16x32_bf16 v[56:59], v[40:43], v[52:55], v[56:59]
    v_fma_f32 v64, v64, s26, -v5
    v_fma_f32 v65, v65, s26, -v5
    v_fma_f32 v66, v66, s26, -v5
    v_fma_f32 v67, v67, s26, -v5
    v_fma_f32 v68, v68, s26, -v5
    v_fma_f32 v69, v69, s26, -v5
    s_waitcnt vmcnt(7)
    buffer_load_dwordx4 v[164:167], v2, s[40:43], s14 offen offset:2048 nt
    v_fma_f32 v70, v70, s26, -v5
    v_fma_f32 v71, v71, s26, -v5
    v_exp_f32 v64, v64
    v_exp_f32 v65, v65
    v_exp_f32 v66, v66
    v_exp_f32 v67, v67
    v_exp_f32 v68, v68
    v_exp_f32 v69, v69
    v_exp_f32 v70, v70
    v_exp_f32 v71, v71
    v_cvt_pk_bf16_f32 v64, v64, v65
    v_cvt_pk_bf16_f32 v65, v66, v67
    v_cvt_pk_bf16_f32 v66, v68, v69
    v_cvt_pk_bf16_f32 v67, v70, v71
    v_fma_f32 v72, v72, s26, -v5
    v_fma_f32 v73, v73, s26, -v5
    v_fma_f32 v74, v74, s26, -v5
    v_fma_f32 v75, v75, s26, -v5
    v_fma_f32 v76, v76, s26, -v5
    v_fma_f32 v77, v77, s26, -v5
    v_fma_f32 v78, v78, s26, -v5
    v_fma_f32 v79, v79, s26, -v5
    v_exp_f32 v72, v72
    v_exp_f32 v73, v73
    s_xor_b32 s14, s100, 20480
    s_waitcnt vmcnt(7)
    buffer_load_dwordx4 v[168:171], v2, s[40:43], s14 offen offset:0 nt
    v_exp_f32 v74, v74
    v_exp_f32 v75, v75
    v_exp_f32 v76, v76
    v_exp_f32 v77, v77
    v_exp_f32 v78, v78
    v_exp_f32 v79, v79
    v_cvt_pk_bf16_f32 v68, v72, v73
    v_cvt_pk_bf16_f32 v69, v74, v75
    v_cvt_pk_bf16_f32 v70, v76, v77
    v_cvt_pk_bf16_f32 v71, v78, v79
    v_fma_f32 v80, v80, s26, -v5
    v_fma_f32 v81, v81, s26, -v5
    v_fma_f32 v82, v82, s26, -v5
    v_fma_f32 v83, v83, s26, -v5
    v_fma_f32 v84, v84, s26, -v5
    v_fma_f32 v85, v85, s26, -v5
    v_fma_f32 v86, v86, s26, -v5
    v_fma_f32 v87, v87, s26, -v5
    v_exp_f32 v80, v80
    v_exp_f32 v81, v81
    v_exp_f32 v82, v82
    v_exp_f32 v83, v83
    v_exp_f32 v84, v84
    v_exp_f32 v85, v85
    s_waitcnt vmcnt(7)
    buffer_load_dwordx4 v[172:175], v2, s[40:43], s14 offen offset:2048 nt
    v_exp_f32 v86, v86
    v_exp_f32 v87, v87
    v_cvt_pk_bf16_f32 v72, v80, v81
    v_cvt_pk_bf16_f32 v73, v82, v83
    v_cvt_pk_bf16_f32 v74, v84, v85
    v_cvt_pk_bf16_f32 v75, v86, v87
    v_fma_f32 v88, v88, s26, -v5
    v_fma_f32 v89, v89, s26, -v5
    v_fma_f32 v90, v90, s26, -v5
    v_fma_f32 v91, v91, s26, -v5
    v_fma_f32 v92, v92, s26, -v5
    v_fma_f32 v93, v93, s26, -v5
    v_fma_f32 v94, v94, s26, -v5
    v_fma_f32 v95, v95, s26, -v5
    v_exp_f32 v88, v88
    v_exp_f32 v89, v89
    v_exp_f32 v90, v90
    v_exp_f32 v91, v91
    v_exp_f32 v92, v92
    v_exp_f32 v93, v93
    v_exp_f32 v94, v94
    v_exp_f32 v95, v95
    v_cvt_pk_bf16_f32 v76, v88, v89
    v_cvt_pk_bf16_f32 v77, v90, v91
    s_xor_b32 s14, s100, 147456
    s_waitcnt vmcnt(7)
    buffer_load_dwordx4 v[176:179], v2, s[40:43], s14 offen offset:0 nt
    v_cvt_pk_bf16_f32 v78, v92, v93
    v_cvt_pk_bf16_f32 v79, v94, v95
    v_fma_f32 v96, v96, s26, -v5
    v_fma_f32 v97, v97, s26, -v5
    v_fma_f32 v98, v98, s26, -v5
    v_fma_f32 v99, v99, s26, -v5
    v_fma_f32 v100, v100, s26, -v5
    v_fma_f32 v101, v101, s26, -v5
    v_fma_f32 v102, v102, s26, -v5
    v_fma_f32 v103, v103, s26, -v5
    v_exp_f32 v96, v96
    v_exp_f32 v97, v97
    v_exp_f32 v98, v98
    v_exp_f32 v99, v99
    v_exp_f32 v100, v100
    v_exp_f32 v101, v101
    v_exp_f32 v102, v102
    v_exp_f32 v103, v103
    v_cvt_pk_bf16_f32 v80, v96, v97
    v_cvt_pk_bf16_f32 v81, v98, v99
    v_cvt_pk_bf16_f32 v82, v100, v101
    v_cvt_pk_bf16_f32 v83, v102, v103
    v_fma_f32 v104, v104, s26, -v5
    v_fma_f32 v105, v105, s26, -v5
    s_waitcnt vmcnt(7)
    buffer_load_dwordx4 v[180:183], v2, s[40:43], s14 offen offset:2048 nt
    buffer_load_dwordx4 a[100:103], off, s[60:63], s7 nt
    v_fma_f32 v106, v106, s26, -v5
    v_fma_f32 v107, v107, s26, -v5
    v_fma_f32 v108, v108, s26, -v5
    v_fma_f32 v109, v109, s26, -v5
    v_fma_f32 v110, v110, s26, -v5
    v_fma_f32 v111, v111, s26, -v5
    v_exp_f32 v104, v104
    v_exp_f32 v105, v105
    v_exp_f32 v106, v106
    v_exp_f32 v107, v107
    v_exp_f32 v108, v108
    v_exp_f32 v109, v109
    v_exp_f32 v110, v110
    v_exp_f32 v111, v111
    v_cvt_pk_bf16_f32 v84, v104, v105
    v_cvt_pk_bf16_f32 v85, v106, v107
    v_cvt_pk_bf16_f32 v86, v108, v109
    v_cvt_pk_bf16_f32 v87, v110, v111
    v_fma_f32 v112, v112, s26, -v5
    v_fma_f32 v113, v113, s26, -v5
    v_fma_f32 v114, v114, s26, -v5
    v_fma_f32 v115, v115, s26, -v5
    v_fma_f32 v116, v116, s26, -v5
    v_fma_f32 v117, v117, s26, -v5
    s_xor_b32 s14, s100, 151552
    s_waitcnt vmcnt(6)
    buffer_load_dwordx4 v[184:187], v2, s[40:43], s14 offen offset:0 nt
    v_cmp_le_u32 vcc, 8, v1
    s_nop 0
    s_bcnt1_i32_b32 vcc_hi, vcc_lo
    s_cmp_ge_u32 vcc_hi, s99
    s_cselect_b64 vcc, -1, 0
    v_fma_f32 v118, v118, s26, -v5
    v_fma_f32 v119, v119, s26, -v5
    v_exp_f32 v112, v112
    v_exp_f32 v113, v113
    v_exp_f32 v114, v114
    v_exp_f32 v115, v115
    v_exp_f32 v116, v116
    v_exp_f32 v117, v117
    v_exp_f32 v118, v118
    v_exp_f32 v119, v119
    v_cvt_pk_bf16_f32 v88, v112, v113
    v_cvt_pk_bf16_f32 v89, v114, v115
    v_cvt_pk_bf16_f32 v90, v116, v117
    v_cvt_pk_bf16_f32 v91, v118, v119
    v_fma_f32 v120, v120, s26, -v5
    v_fma_f32 v121, v121, s26, -v5
    v_fma_f32 v122, v122, s26, -v5
    v_fma_f32 v123, v123, s26, -v5
    v_fma_f32 v124, v124, s26, -v5
    v_fma_f32 v125, v125, s26, -v5
    v_fma_f32 v126, v126, s26, -v5
    v_fma_f32 v127, v127, s26, -v5
    v_exp_f32 v120, v120
    v_exp_f32 v121, v121
    s_cbranch_vccnz L_loose106
    s_waitcnt vmcnt(6)
L_loose106:
    buffer_load_dwordx4 v[188:191], v2, s[40:43], s14 offen offset:2048 nt
    v_mov_b32 v1, 16
    s_mov_b64 exec, 1
    buffer_store_byte v1, off, s[60:63], s97
    s_mov_b64 exec, -1
    buffer_load_ubyte v1, v0, s[60:63], s96 offen nt
    v_exp_f32 v122, v122
    v_exp_f32 v123, v123
    v_exp_f32 v124, v124
    v_exp_f32 v125, v125
    v_exp_f32 v126, v126
    v_exp_f32 v127, v127
    v_cvt_pk_bf16_f32 v92, v120, v121
    v_cvt_pk_bf16_f32 v93, v122, v123
    v_cvt_pk_bf16_f32 v94, v124, v125
    v_cvt_pk_bf16_f32 v95, v126, v127
    v_mfma_f32_16x16x32_bf16 v[60:63], v[40:43], v[64:67], 0
    v_mfma_f32_16x16x32_bf16 v[60:63], v[40:43], v[68:71], v[60:63]
    v_mfma_f32_16x16x32_bf16 v[60:63], v[40:43], v[72:75], v[60:63]
    v_mfma_f32_16x16x32_bf16 v[60:63], v[40:43], v[76:79], v[60:63]
    v_mfma_f32_16x16x32_bf16 v[60:63], v[40:43], v[80:83], v[60:63]
    v_mfma_f32_16x16x32_bf16 v[60:63], v[40:43], v[84:87], v[60:63]
    v_mfma_f32_16x16x32_bf16 v[60:63], v[40:43], v[88:91], v[60:63]
    v_mfma_f32_16x16x32_bf16 v[60:63], v[40:43], v[92:95], v[60:63]
    v_and_b32 v10, 3, v0
    v_mul_u32_u24 v10, 560, v10
    v_lshl_add_u32 v10, v6, 7, v10
    s_mul_i32 s8, s3, 2240
    v_add_u32 v10, s8, v10
    s_mul_i32 s8, s3, 560
    s_cbranch_vccnz L_loose108
    s_waitcnt vmcnt(8)
L_loose108:
    buffer_load_dwordx4 v[192:195], v2, s[44:47], s95 offen offset:0 nt
    v_lshl_add_u32 v11, v0, 4, s8
    s_cmp_eq_u32 s3, 0
    s_cselect_b32 s8, 1.0, 0
    v_and_b32 v56, 0xffffff00, v4
    v_sub_f32 v57, v4, v56
    v_mul_f32 v56, s8, v56
    v_mul_f32 v57, s8, v57
    v_and_b32 v60, 0xffffff00, v5
    v_sub_f32 v61, v5, v60
    v_mul_f32 v60, s8, v60
    v_mul_f32 v61, s8, v61
    s_mov_b64 exec, 15
    ds_write_b128 v10, v[56:59] offset:512
    ds_write_b128 v10, v[60:63] offset:528
    s_mov_b64 exec, -1
    s_lshl2_add_u32 s8, s9, s3
    s_lshl3_add_u32 s8, s8, s12
    s_lshl2_add_u32 s8, s8, s11
    s_lshl_b32 s10, s8, 9
    s_add_u32 s10, s10, 2097152
    v_lshl_add_u32 v7, v0, 4, s10
    s_lshl_b32 s8, s8, 4
    s_add_u32 s8, s8, 1114112
    v_and_b32 v4, 1, v0
    s_waitcnt vmcnt(10)
    s_cbranch_vccnz L_loose109
    s_waitcnt vmcnt(8)
L_loose109:
    buffer_load_dwordx4 v[196:199], v2, s[44:47], s95 offen offset:2048 nt
    s_mov_b32 exec_lo, 0
    v_lshl_add_u32 v7, v4, 14, s8
    s_mov_b32 exec_lo, -1
    s_mov_b32 exec_hi, 0
    v_add_u32 v7, s6, v7
    s_mov_b32 exec_hi, -1
    s_mov_b32 s68, 0x000f000f
    s_mov_b32 s69, 0x000f000f
    v_perm_b32 v16, v132, v128, s16
    v_perm_b32 v20, v132, v128, s17
    v_perm_b32 v24, v133, v129, s16
    v_perm_b32 v28, v133, v129, s17
    v_perm_b32 v32, v134, v130, s16
    v_perm_b32 v36, v134, v130, s17
    v_perm_b32 v40, v135, v131, s16
    v_perm_b32 v44, v135, v131, s17
    v_perm_b32 v17, v140, v136, s16
    v_perm_b32 v21, v140, v136, s17
    v_perm_b32 v25, v141, v137, s16
    v_perm_b32 v29, v141, v137, s17
    v_perm_b32 v33, v142, v138, s16
    v_perm_b32 v37, v142, v138, s17
    v_perm_b32 v41, v143, v139, s16
    v_perm_b32 v45, v143, v139, s17
    s_xor_b32 s14, s95, 4096
    s_waitcnt vmcnt(10)
    s_cbranch_vccnz L_loose110
    s_waitcnt vmcnt(8)
L_loose110:
    buffer_load_dwordx4 v[200:203], v2, s[44:47], s14 offen offset:0 nt
    v_perm_b32 v18, v148, v144, s16
    v_perm_b32 v22, v148, v144, s17
    v_perm_b32 v26, v149, v145, s16
    v_perm_b32 v30, v149, v145, s17
    v_perm_b32 v34, v150, v146, s16
    v_perm_b32 v38, v150, v146, s17
    v_perm_b32 v42, v151, v147, s16
    v_perm_b32 v46, v151, v147, s17
    v_perm_b32 v19, v156, v152, s16
    v_perm_b32 v23, v156, v152, s17
    v_perm_b32 v27, v157, v153, s16
    v_perm_b32 v31, v157, v153, s17
    v_perm_b32 v35, v158, v154, s16
    v_perm_b32 v39, v158, v154, s17
    v_perm_b32 v43, v159, v155, s16
    v_perm_b32 v47, v159, v155, s17
    v_mfma_f32_16x16x32_bf16 v[96:99], v[16:19], v[48:51], 0
    v_mfma_f32_16x16x32_bf16 v[100:103], v[20:23], v[48:51], 0
    v_mfma_f32_16x16x32_bf16 v[104:107], v[24:27], v[48:51], 0
    v_mfma_f32_16x16x32_bf16 v[108:111], v[28:31], v[48:51], 0
    v_mfma_f32_16x16x32_bf16 v[112:115], v[32:35], v[48:51], 0
    v_mfma_f32_16x16x32_bf16 v[116:119], v[36:39], v[48:51], 0
    v_mfma_f32_16x16x32_bf16 v[120:123], v[40:43], v[48:51], 0
    v_mfma_f32_16x16x32_bf16 v[124:127], v[44:47], v[48:51], 0
    s_waitcnt vmcnt(10)
    s_cbranch_vccnz L_loose111
    s_waitcnt vmcnt(8)
L_loose111:
    buffer_load_dwordx4 v[204:207], v2, s[44:47], s14 offen offset:2048 nt
    v_perm_b32 v16, v164, v160, s16
    v_perm_b32 v20, v164, v160, s17
    v_perm_b32 v24, v165, v161, s16
    v_perm_b32 v28, v165, v161, s17
    v_perm_b32 v32, v166, v162, s16
    v_perm_b32 v36, v166, v162, s17
    v_perm_b32 v40, v167, v163, s16
    v_perm_b32 v44, v167, v163, s17
    v_perm_b32 v17, v172, v168, s16
    v_perm_b32 v21, v172, v168, s17
    v_perm_b32 v25, v173, v169, s16
    v_perm_b32 v29, v173, v169, s17
    v_perm_b32 v33, v174, v170, s16
    v_perm_b32 v37, v174, v170, s17
    v_perm_b32 v41, v175, v171, s16
    v_perm_b32 v45, v175, v171, s17
    s_xor_b32 s14, s95, 131072
    s_waitcnt vmcnt(10)
    s_cbranch_vccnz L_loose112
    s_waitcnt vmcnt(7)
L_loose112:
    buffer_load_dwordx4 v[208:211], v2, s[44:47], s14 offen offset:0 nt
    s_waitcnt vmcnt(10)
    s_cbranch_vccnz L_loose113
    s_waitcnt vmcnt(7)
L_loose113:
    buffer_load_dwordx4 v[212:215], v2, s[44:47], s14 offen offset:2048 nt
    v_perm_b32 v18, v180, v176, s16
    v_perm_b32 v22, v180, v176, s17
    v_perm_b32 v26, v181, v177, s16
    v_perm_b32 v30, v181, v177, s17
    v_perm_b32 v34, v182, v178, s16
    v_perm_b32 v38, v182, v178, s17
    v_perm_b32 v42, v183, v179, s16
    v_perm_b32 v46, v183, v179, s17
    s_xor_b32 s14, s95, 135168
    s_waitcnt vmcnt(9)
    s_cbranch_vccnz L_loose114
    s_waitcnt vmcnt(5)
L_loose114:
    buffer_load_dwordx4 v[216:219], v2, s[44:47], s14 offen offset:0 nt
    v_cmp_le_u32 vcc, 16, v1
    s_nop 0
    s_bcnt1_i32_b32 vcc_hi, vcc_lo
    s_cmp_ge_u32 vcc_hi, s99
    s_cselect_b64 vcc, -1, 0
    s_waitcnt vmcnt(9)
    s_cbranch_vccnz L_loose115
    s_waitcnt vmcnt(5)
L_loose115:
    buffer_load_dwordx4 v[220:223], v2, s[44:47], s14 offen offset:2048 nt
    s_waitcnt vmcnt(8)
    v_mov_b32 v1, 24
    s_mov_b64 exec, 1
    buffer_store_byte v1, off, s[60:63], s97
    s_mov_b64 exec, -1
    buffer_load_ubyte v1, v0, s[60:63], s96 offen nt
    v_perm_b32 v19, v188, v184, s16
    v_perm_b32 v23, v188, v184, s17
    v_perm_b32 v27, v189, v185, s16
    v_perm_b32 v31, v189, v185, s17
    v_perm_b32 v35, v190, v186, s16
    v_perm_b32 v39, v190, v186, s17
    v_perm_b32 v43, v191, v187, s16
    v_perm_b32 v47, v191, v187, s17
    v_mfma_f32_16x16x32_bf16 v[96:99], v[16:19], v[52:55], v[96:99]
    v_mfma_f32_16x16x32_bf16 v[100:103], v[20:23], v[52:55], v[100:103]
    v_mfma_f32_16x16x32_bf16 v[104:107], v[24:27], v[52:55], v[104:107]
    v_mfma_f32_16x16x32_bf16 v[108:111], v[28:31], v[52:55], v[108:111]
    v_mfma_f32_16x16x32_bf16 v[112:115], v[32:35], v[52:55], v[112:115]
    v_mfma_f32_16x16x32_bf16 v[116:119], v[36:39], v[52:55], v[116:119]
    v_mfma_f32_16x16x32_bf16 v[120:123], v[40:43], v[52:55], v[120:123]
    v_mfma_f32_16x16x32_bf16 v[124:127], v[44:47], v[52:55], v[124:127]
    s_mov_b32 s98, vcc_lo
    s_cmp_lg_u32 s101, 0
    s_cbranch_scc1 L_ok_sib
    v_accvgpr_read_b32 v16, a100
    v_accvgpr_read_b32 v17, a101
    v_accvgpr_read_b32 v18, a102
    v_accvgpr_read_b32 v19, a103
L_chk_sib:
    v_bitop3_b32 v20, v16, v17, s18 bitop3:0x7e
    v_bitop3_b32 v21, v18, v19, s18 bitop3:0x7e
    v_or_b32 v20, v20, v21
    v_cmp_ne_u32 vcc, 0, v20
    s_nop 0
    s_cbranch_vccnz L_retry_sib
L_ok_sib:
    s_mov_b32 vcc_lo, s98
    s_mov_b32 vcc_hi, s98
    s_xor_b32 s14, s95, 524288
    s_waitcnt vmcnt(9)
    s_cbranch_vccnz L_loose117
    s_waitcnt vmcnt(7)
L_loose117:
    buffer_load_dwordx4 v[224:227], v2, s[44:47], s14 offen offset:0 nt
    s_mov_b64 exec, s[68:69]
    ds_write_b128 v10, v[96:99] offset:0
    ds_write_b128 v10, v[100:103] offset:16
    ds_write_b128 v10, v[104:107] offset:32
    ds_write_b128 v10, v[108:111] offset:48
    ds_write_b128 v10, v[112:115] offset:64
    ds_write_b128 v10, v[116:119] offset:80
    ds_write_b128 v10, v[120:123] offset:96
    ds_write_b128 v10, v[124:127] offset:112
    s_mov_b32 exec_lo, -1
    s_mov_b32 exec_hi, 3
    s_cmp_lg_u32 s101, 0
    s_waitcnt lgkmcnt(0)
    s_barrier
    ds_read_b128 v[16:19], v11 offset:0
    ds_read_b128 v[20:23], v11 offset:2240
    ds_read_b128 v[24:27], v11 offset:4480
    ds_read_b128 v[28:31], v11 offset:6720
    s_waitcnt lgkmcnt(0)
    v_pk_add_f32 v[32:33], v[16:17], v[20:21]
    v_pk_add_f32 v[34:35], v[18:19], v[22:23]
    v_pk_add_f32 v[36:37], v[24:25], v[28:29]
    v_pk_add_f32 v[38:39], v[26:27], v[30:31]
    v_pk_add_f32 v[32:33], v[32:33], v[36:37]
    v_pk_add_f32 v[34:35], v[34:35], v[38:39]
    v_perm_b32 v40, v32, v3, s23
    v_perm_b32 v41, v33, v3, s24
    v_perm_b32 v42, v34, v3, s25
    v_perm_b32 v43, v35, v3, s22
    s_cbranch_scc1 L_far_st0
    buffer_store_dwordx4 v[40:43], v7, s[60:63], 0 offen
L_st_done0:
    s_mov_b64 exec, -1
    s_waitcnt vmcnt(10)
    s_cbranch_vccnz L_loose118
    s_waitcnt vmcnt(8)
L_loose118:
    buffer_load_dwordx4 v[228:231], v2, s[44:47], s14 offen offset:2048 nt
    v_subrev_u32 v7, s6, v7
    v_lshrrev_b32 v4, 5, v0
    v_mul_u32_u24 v4, 272, v4
    v_and_b32 v5, 31, v0
    v_lshl_add_u32 v4, v5, 3, v4
    s_mul_i32 s8, s3, 544
    s_add_u32 s8, s8, 20992
    v_add_u32 v4, s8, v4
    v_and_b32 v5, 7, v0
    v_mul_u32_u24 v5, 272, v5
    v_lshl_add_u32 v5, v6, 4, v5
    s_mul_i32 s8, s3, 1280
    v_lshl_add_u32 v6, v6, 4, s8
    v_and_b32 v16, 15, v0
    v_mul_u32_u24 v16, 80, v16
    v_add_u32 v6, v6, v16
    v_perm_b32 v16, v196, v192, s16
    v_perm_b32 v20, v196, v192, s17
    v_perm_b32 v24, v197, v193, s16
    v_perm_b32 v28, v197, v193, s17
    v_perm_b32 v32, v198, v194, s16
    v_perm_b32 v36, v198, v194, s17
    v_perm_b32 v40, v199, v195, s16
    v_perm_b32 v44, v199, v195, s17
    s_xor_b32 s14, s95, 528384
    s_waitcnt vmcnt(10)
    s_cbranch_vccnz L_loose119
    s_waitcnt vmcnt(8)
L_loose119:
    buffer_load_dwordx4 v[232:235], v2, s[44:47], s14 offen offset:0 nt
    s_waitcnt vmcnt(10)
    s_cbranch_vccnz L_loose120
    s_waitcnt vmcnt(8)
L_loose120:
    buffer_load_dwordx4 v[236:239], v2, s[44:47], s14 offen offset:2048 nt
    v_perm_b32 v17, v204, v200, s16
    v_perm_b32 v21, v204, v200, s17
    v_perm_b32 v25, v205, v201, s16
    v_perm_b32 v29, v205, v201, s17
    v_perm_b32 v33, v206, v202, s16
    v_perm_b32 v37, v206, v202, s17
    v_perm_b32 v41, v207, v203, s16
    v_perm_b32 v45, v207, v203, s17
    s_xor_b32 s14, s95, 655360
    s_waitcnt vmcnt(10)
    s_cbranch_vccnz L_loose121
    s_waitcnt vmcnt(8)
L_loose121:
    buffer_load_dwordx4 v[240:243], v2, s[44:47], s14 offen offset:0 nt
    s_waitcnt vmcnt(10)
    s_cbranch_vccnz L_loose122
    s_waitcnt vmcnt(8)
L_loose122:
    buffer_load_dwordx4 v[244:247], v2, s[44:47], s14 offen offset:2048 nt
    v_perm_b32 v18, v212, v208, s16
    v_perm_b32 v22, v212, v208, s17
    v_perm_b32 v26, v213, v209, s16
    v_perm_b32 v30, v213, v209, s17
    v_perm_b32 v34, v214, v210, s16
    v_perm_b32 v38, v214, v210, s17
    v_perm_b32 v42, v215, v211, s16
    v_perm_b32 v46, v215, v211, s17
    s_xor_b32 s14, s95, 659456
    s_waitcnt vmcnt(10)
    s_cbranch_vccnz L_loose123
    s_waitcnt vmcnt(6)
L_loose123:
    buffer_load_dwordx4 v[248:251], v2, s[44:47], s14 offen offset:0 nt
    v_cmp_le_u32 vcc, 24, v1
    s_nop 0
    s_bcnt1_i32_b32 vcc_hi, vcc_lo
    s_cmp_ge_u32 vcc_hi, s99
    s_cselect_b64 vcc, -1, 0
    s_waitcnt vmcnt(10)
    s_cbranch_vccnz L_loose124
    s_waitcnt vmcnt(5)
L_loose124:
    buffer_load_dwordx4 v[252:255], v2, s[44:47], s14 offen offset:2048 nt
    s_waitcnt vmcnt(9)
    v_mov_b32 v1, 32
    s_mov_b64 exec, 1
    buffer_store_byte v1, off, s[60:63], s97
    s_mov_b64 exec, -1
    buffer_load_ubyte v1, v0, s[60:63], s96 offen nt
    v_perm_b32 v19, v220, v216, s16
    v_perm_b32 v23, v220, v216, s17
    v_perm_b32 v27, v221, v217, s16
    v_perm_b32 v31, v221, v217, s17
    v_perm_b32 v35, v222, v218, s16
    v_perm_b32 v39, v222, v218, s17
    v_perm_b32 v43, v223, v219, s16
    v_perm_b32 v47, v223, v219, s17
    v_mfma_f32_16x16x32_bf16 v[96:99], v[16:19], v[64:67], 0
    v_mfma_f32_16x16x32_bf16 v[100:103], v[20:23], v[64:67], 0
    v_mfma_f32_16x16x32_bf16 v[104:107], v[24:27], v[64:67], 0
    v_mfma_f32_16x16x32_bf16 v[108:111], v[28:31], v[64:67], 0
    v_mfma_f32_16x16x32_bf16 v[112:115], v[32:35], v[64:67], 0
    v_mfma_f32_16x16x32_bf16 v[116:119], v[36:39], v[64:67], 0
    v_mfma_f32_16x16x32_bf16 v[120:123], v[40:43], v[64:67], 0
    v_mfma_f32_16x16x32_bf16 v[124:127], v[44:47], v[64:67], 0
    s_xor_b32 s14, s95, 262144
    s_waitcnt vmcnt(10)
    s_cbranch_vccnz L_loose126
    s_waitcnt vmcnt(7)
L_loose126:
    buffer_load_dwordx4 v[128:131], v2, s[44:47], s14 offen offset:0 nt
    s_waitcnt vmcnt(9)
    s_cbranch_vccnz L_loose127
    s_waitcnt vmcnt(7)
L_loose127:
    buffer_load_dwordx4 v[132:135], v2, s[44:47], s14 offen offset:2048 nt
    v_perm_b32 v16, v228, v224, s16
    v_perm_b32 v20, v228, v224, s17
    v_perm_b32 v24, v229, v225, s16
    v_perm_b32 v28, v229, v225, s17
    v_perm_b32 v32, v230, v226, s16
    v_perm_b32 v36, v230, v226, s17
    v_perm_b32 v40, v231, v227, s16
    v_perm_b32 v44, v231, v227, s17
    s_xor_b32 s14, s95, 266240
    s_waitcnt vmcnt(9)
    s_cbranch_vccnz L_loose128
    s_waitcnt vmcnt(7)
L_loose128:
    buffer_load_dwordx4 v[136:139], v2, s[44:47], s14 offen offset:0 nt
    s_waitcnt vmcnt(9)
    s_cbranch_vccnz L_loose129
    s_waitcnt vmcnt(7)
L_loose129:
    buffer_load_dwordx4 v[140:143], v2, s[44:47], s14 offen offset:2048 nt
    v_perm_b32 v17, v236, v232, s16
    v_perm_b32 v21, v236, v232, s17
    v_perm_b32 v25, v237, v233, s16
    v_perm_b32 v29, v237, v233, s17
    v_perm_b32 v33, v238, v234, s16
    v_perm_b32 v37, v238, v234, s17
    v_perm_b32 v41, v239, v235, s16
    v_perm_b32 v45, v239, v235, s17
    s_xor_b32 s14, s95, 393216
    s_waitcnt vmcnt(9)
    s_cbranch_vccnz L_loose130
    s_waitcnt vmcnt(7)
L_loose130:
    buffer_load_dwordx4 v[144:147], v2, s[44:47], s14 offen offset:0 nt
    s_waitcnt vmcnt(9)
    s_cbranch_vccnz L_loose131
    s_waitcnt vmcnt(7)
L_loose131:
    buffer_load_dwordx4 v[148:151], v2, s[44:47], s14 offen offset:2048 nt
    v_perm_b32 v18, v244, v240, s16
    v_perm_b32 v22, v244, v240, s17
    v_perm_b32 v26, v245, v241, s16
    v_perm_b32 v30, v245, v241, s17
    v_perm_b32 v34, v246, v242, s16
    v_perm_b32 v38, v246, v242, s17
    v_perm_b32 v42, v247, v243, s16
    v_perm_b32 v46, v247, v243, s17
    s_xor_b32 s14, s95, 397312
    s_waitcnt vmcnt(9)
    s_cbranch_vccnz L_loose132
    s_waitcnt vmcnt(5)
L_loose132:
    buffer_load_dwordx4 v[152:155], v2, s[44:47], s14 offen offset:0 nt
    v_cmp_le_u32 vcc, 32, v1
    s_nop 0
    s_bcnt1_i32_b32 vcc_hi, vcc_lo
    s_cmp_ge_u32 vcc_hi, s99
    s_cselect_b64 vcc, -1, 0
    s_waitcnt vmcnt(9)
    s_cbranch_vccnz L_loose133
    s_waitcnt vmcnt(5)
L_loose133:
    buffer_load_dwordx4 v[156:159], v2, s[44:47], s14 offen offset:2048 nt
    s_waitcnt vmcnt(8)
    v_mov_b32 v1, 40
    s_mov_b64 exec, 1
    buffer_store_byte v1, off, s[60:63], s97
    s_mov_b64 exec, -1
    buffer_load_ubyte v1, v0, s[60:63], s96 offen nt
    v_perm_b32 v19, v252, v248, s16
    v_perm_b32 v23, v252, v248, s17
    v_perm_b32 v27, v253, v249, s16
    v_perm_b32 v31, v253, v249, s17
    v_perm_b32 v35, v254, v250, s16
    v_perm_b32 v39, v254, v250, s17
    v_perm_b32 v43, v255, v251, s16
    v_perm_b32 v47, v255, v251, s17
    v_mfma_f32_16x16x32_bf16 v[96:99], v[16:19], v[68:71], v[96:99]
    v_mfma_f32_16x16x32_bf16 v[100:103], v[20:23], v[68:71], v[100:103]
    v_mfma_f32_16x16x32_bf16 v[104:107], v[24:27], v[68:71], v[104:107]
    v_mfma_f32_16x16x32_bf16 v[108:111], v[28:31], v[68:71], v[108:111]
    v_mfma_f32_16x16x32_bf16 v[112:115], v[32:35], v[68:71], v[112:115]
    v_mfma_f32_16x16x32_bf16 v[116:119], v[36:39], v[68:71], v[116:119]
    v_mfma_f32_16x16x32_bf16 v[120:123], v[40:43], v[68:71], v[120:123]
    v_mfma_f32_16x16x32_bf16 v[124:127], v[44:47], v[68:71], v[124:127]
    s_xor_b32 s14, s95, 786432
    s_waitcnt vmcnt(9)
    s_cbranch_vccnz L_loose135
    s_waitcnt vmcnt(7)
L_loose135:
    buffer_load_dwordx4 v[160:163], v2, s[44:47], s14 offen offset:0 nt
    s_waitcnt vmcnt(9)
    s_cbranch_vccnz L_loose136
    s_waitcnt vmcnt(7)
L_loose136:
    buffer_load_dwordx4 v[164:167], v2, s[44:47], s14 offen offset:2048 nt
    buffer_load_dwordx4 a[64:67], v13, s[60:63], s6 offen offset:0
    buffer_load_dwordx4 a[68:71], v13, s[60:63], s6 offen offset:512
    buffer_load_dwordx4 a[72:75], v13, s[60:63], s6 offen offset:1024
    buffer_load_dwordx4 a[76:79], v13, s[60:63], s6 offen offset:1536
    buffer_load_dwordx4 v[48:51], v12, s[60:63], 0 offen offset:0
    buffer_load_dwordx4 v[52:55], v12, s[60:63], 0 offen offset:16
    buffer_load_dwordx4 v[56:59], v12, s[60:63], 0 offen offset:32
    buffer_load_dwordx4 v[60:63], v12, s[60:63], 0 offen offset:48
    v_perm_b32 v16, v132, v128, s16
    v_perm_b32 v20, v132, v128, s17
    v_perm_b32 v24, v133, v129, s16
    v_perm_b32 v28, v133, v129, s17
    v_perm_b32 v32, v134, v130, s16
    v_perm_b32 v36, v134, v130, s17
    v_perm_b32 v40, v135, v131, s16
    v_perm_b32 v44, v135, v131, s17
    s_xor_b32 s14, s95, 790528
    s_waitcnt vmcnt(17)
    s_cbranch_vccnz L_loose138
    s_waitcnt vmcnt(15)
L_loose138:
    buffer_load_dwordx4 v[168:171], v2, s[44:47], s14 offen offset:0 nt
    s_waitcnt vmcnt(17)
    s_cbranch_vccnz L_loose139
    s_waitcnt vmcnt(15)
L_loose139:
    buffer_load_dwordx4 v[172:175], v2, s[44:47], s14 offen offset:2048 nt
    v_perm_b32 v17, v140, v136, s16
    v_perm_b32 v21, v140, v136, s17
    v_perm_b32 v25, v141, v137, s16
    v_perm_b32 v29, v141, v137, s17
    v_perm_b32 v33, v142, v138, s16
    v_perm_b32 v37, v142, v138, s17
    v_perm_b32 v41, v143, v139, s16
    v_perm_b32 v45, v143, v139, s17
    s_xor_b32 s14, s95, 917504
    s_waitcnt vmcnt(17)
    s_cbranch_vccnz L_loose140
    s_waitcnt vmcnt(15)
L_loose140:
    buffer_load_dwordx4 v[176:179], v2, s[44:47], s14 offen offset:0 nt
    s_waitcnt vmcnt(17)
    s_cbranch_vccnz L_loose141
    s_waitcnt vmcnt(15)
L_loose141:
    buffer_load_dwordx4 v[180:183], v2, s[44:47], s14 offen offset:2048 nt
    v_perm_b32 v18, v148, v144, s16
    v_perm_b32 v22, v148, v144, s17
    v_perm_b32 v26, v149, v145, s16
    v_perm_b32 v30, v149, v145, s17
    v_perm_b32 v34, v150, v146, s16
    v_perm_b32 v38, v150, v146, s17
    v_perm_b32 v42, v151, v147, s16
    v_perm_b32 v46, v151, v147, s17
    s_xor_b32 s14, s95, 921600
    s_waitcnt vmcnt(17)
    s_cbranch_vccnz L_loose142
    s_waitcnt vmcnt(13)
L_loose142:
    buffer_load_dwordx4 v[184:187], v2, s[44:47], s14 offen offset:0 nt
    v_cmp_le_u32 vcc, 40, v1
    s_nop 0
    s_bcnt1_i32_b32 vcc_hi, vcc_lo
    s_cmp_ge_u32 vcc_hi, s99
    s_cselect_b64 vcc, -1, 0
    s_waitcnt vmcnt(17)
    s_cbranch_vccnz L_loose143
    s_waitcnt vmcnt(13)
L_loose143:
    buffer_load_dwordx4 v[188:191], v2, s[44:47], s14 offen offset:2048 nt
    s_waitcnt vmcnt(16)
    v_mov_b32 v1, 48
    s_mov_b64 exec, 1
    buffer_store_byte v1, off, s[60:63], s97
    s_mov_b64 exec, -1
    buffer_load_ubyte v1, v0, s[60:63], s96 offen nt
    v_perm_b32 v19, v156, v152, s16
    v_perm_b32 v23, v156, v152, s17
    v_perm_b32 v27, v157, v153, s16
    v_perm_b32 v31, v157, v153, s17
    v_perm_b32 v35, v158, v154, s16
    v_perm_b32 v39, v158, v154, s17
    v_perm_b32 v43, v159, v155, s16
    v_perm_b32 v47, v159, v155, s17
    v_mfma_f32_16x16x32_bf16 v[96:99], v[16:19], v[72:75], v[96:99]
    v_mfma_f32_16x16x32_bf16 v[100:103], v[20:23], v[72:75], v[100:103]
    v_mfma_f32_16x16x32_bf16 v[104:107], v[24:27], v[72:75], v[104:107]
    v_mfma_f32_16x16x32_bf16 v[108:111], v[28:31], v[72:75], v[108:111]
    v_mfma_f32_16x16x32_bf16 v[112:115], v[32:35], v[72:75], v[112:115]
    v_mfma_f32_16x16x32_bf16 v[116:119], v[36:39], v[72:75], v[116:119]
    v_mfma_f32_16x16x32_bf16 v[120:123], v[40:43], v[72:75], v[120:123]
    v_mfma_f32_16x16x32_bf16 v[124:127], v[44:47], v[72:75], v[124:127]
    s_xor_b32 s14, s95, 16384
    s_waitcnt vmcnt(17)
    s_cbranch_vccnz L_loose145
    s_waitcnt vmcnt(7)
L_loose145:
    buffer_load_dwordx4 v[192:195], v2, s[44:47], s14 offen offset:0 nt
    s_waitcnt vmcnt(17)
    s_cbranch_vccnz L_loose146
    s_waitcnt vmcnt(7)
L_loose146:
    buffer_load_dwordx4 v[196:199], v2, s[44:47], s14 offen offset:2048 nt
    s_xor_b32 s14, s95, 20480
    s_waitcnt vmcnt(9)
    s_cbranch_vccnz L_loose147
    s_waitcnt vmcnt(7)
L_loose147:
    buffer_load_dwordx4 v[200:203], v2, s[44:47], s14 offen offset:0 nt
    v_accvgpr_read_b32 v16, a64
    v_accvgpr_read_b32 v17, a65
    v_accvgpr_read_b32 v18, a66
    v_accvgpr_read_b32 v19, a67
    v_accvgpr_read_b32 v20, a68
    v_accvgpr_read_b32 v21, a69
    v_accvgpr_read_b32 v22, a70
    v_accvgpr_read_b32 v23, a71
    v_accvgpr_read_b32 v24, a72
    v_accvgpr_read_b32 v25, a73
    v_accvgpr_read_b32 v26, a74
    v_accvgpr_read_b32 v27, a75
    v_accvgpr_read_b32 v28, a76
    v_accvgpr_read_b32 v29, a77
    v_accvgpr_read_b32 v30, a78
    v_accvgpr_read_b32 v31, a79
    s_mov_b32 s98, vcc_lo
L_chk_a1:
    v_bitop3_b32 v32, v48, v52, s19 bitop3:0x7e
    v_bitop3_b32 v33, v49, v53, s20 bitop3:0x7e
    v_bitop3_b32 v34, v50, v54, s21 bitop3:0x7e
    v_or3_b32 v32, v32, v33, v34
    v_bitop3_b32 v33, v51, v55, s18 bitop3:0x7e
    v_bitop3_b32 v34, v56, v60, s19 bitop3:0x7e
    v_or3_b32 v32, v32, v33, v34
    v_bitop3_b32 v33, v57, v61, s20 bitop3:0x7e
    v_bitop3_b32 v34, v58, v62, s21 bitop3:0x7e
    v_or3_b32 v32, v32, v33, v34
    v_bitop3_b32 v33, v59, v63, s18 bitop3:0x7e
    v_bitop3_b32 v34, v16, v20, s19 bitop3:0x7e
    v_or3_b32 v32, v32, v33, v34
    v_bitop3_b32 v33, v17, v21, s20 bitop3:0x7e
    v_bitop3_b32 v34, v18, v22, s21 bitop3:0x7e
    v_or3_b32 v32, v32, v33, v34
    v_bitop3_b32 v33, v19, v23, s18 bitop3:0x7e
    v_bitop3_b32 v34, v24, v28, s19 bitop3:0x7e
    v_or3_b32 v32, v32, v33, v34
    v_bitop3_b32 v33, v25, v29, s20 bitop3:0x7e
    v_bitop3_b32 v34, v26, v30, s21 bitop3:0x7e
    v_or3_b32 v32, v32, v33, v34
    v_bitop3_b32 v33, v27, v31, s18 bitop3:0x7e
    v_bitop3_b32 v32, v32, v33, s93 bitop3:0x54
    v_cmp_ne_u32 vcc, 0, v32
    s_nop 0
    s_cbranch_vccnz L_retry_a1
L_ok_a1:
    s_mov_b32 vcc_lo, s98
    s_mov_b32 vcc_hi, s98
    s_waitcnt vmcnt(9)
    s_cbranch_vccnz L_loose148
    s_waitcnt vmcnt(7)
L_loose148:
    buffer_load_dwordx4 v[204:207], v2, s[44:47], s14 offen offset:2048 nt
    v_and_b32 v48, s93, v48
    v_and_b32 v49, s93, v49
    v_and_b32 v50, s93, v50
    v_add_f32 v48, v48, v49
    v_and_b32 v52, s93, v52
    v_and_b32 v53, s93, v53
    v_and_b32 v54, s93, v54
    v_add_f32 v52, v52, v53
    v_and_b32 v56, s93, v56
    v_and_b32 v57, s93, v57
    v_and_b32 v58, s93, v58
    v_add_f32 v56, v56, v57
    v_and_b32 v60, s93, v60
    v_and_b32 v61, s93, v61
    v_and_b32 v62, s93, v62
    v_add_f32 v60, v60, v61
    v_max3_f32 v32, v48, v52, v56
    v_max_f32 v32, v32, v60
    v_sub_f32 v48, v48, v32
    v_sub_f32 v52, v52, v32
    v_sub_f32 v56, v56, v32
    v_sub_f32 v60, v60, v32
    v_exp_f32 v48, v48
    v_exp_f32 v52, v52
    s_xor_b32 s14, s95, 147456
    s_waitcnt vmcnt(9)
    s_cbranch_vccnz L_loose149
    s_waitcnt vmcnt(7)
L_loose149:
    buffer_load_dwordx4 v[208:211], v2, s[44:47], s14 offen offset:0 nt
    v_exp_f32 v56, v56
    v_exp_f32 v60, v60
    v_mul_f32 v32, v48, v50
    v_fmac_f32 v32, v52, v54
    v_fmac_f32 v32, v56, v58
    v_fmac_f32 v32, v60, v62
    v_rcp_f32 v32, v32
    s_nop 0
    v_mul_f32 v48, v48, v32
    v_mul_f32 v52, v52, v32
    v_mul_f32 v56, v56, v32
    v_mul_f32 v60, v60, v32
    v_and_b32 v16, s93, v16
    v_and_b32 v17, s93, v17
    v_and_b32 v18, s93, v18
    v_and_b32 v19, s93, v19
    v_and_b32 v20, s93, v20
    v_and_b32 v21, s93, v21
    v_and_b32 v22, s93, v22
    v_and_b32 v23, s93, v23
    v_and_b32 v24, s93, v24
    v_and_b32 v25, s93, v25
    v_and_b32 v26, s93, v26
    v_and_b32 v27, s93, v27
    v_and_b32 v28, s93, v28
    s_waitcnt vmcnt(9)
    s_cbranch_vccnz L_loose150
    s_waitcnt vmcnt(7)
L_loose150:
    buffer_load_dwordx4 v[212:215], v2, s[44:47], s14 offen offset:2048 nt
    v_and_b32 v29, s93, v29
    v_and_b32 v30, s93, v30
    v_and_b32 v31, s93, v31
    v_pk_mul_f32 v[32:33], v[16:17], v[48:49] op_sel_hi:[1,0]
    v_pk_mul_f32 v[34:35], v[18:19], v[48:49] op_sel_hi:[1,0]
    v_pk_fma_f32 v[32:33], v[20:21], v[52:53], v[32:33] op_sel_hi:[1,0,1]
    v_pk_fma_f32 v[34:35], v[22:23], v[52:53], v[34:35] op_sel_hi:[1,0,1]
    v_pk_fma_f32 v[32:33], v[24:25], v[56:57], v[32:33] op_sel_hi:[1,0,1]
    v_pk_fma_f32 v[34:35], v[26:27], v[56:57], v[34:35] op_sel_hi:[1,0,1]
    v_pk_fma_f32 v[32:33], v[28:29], v[60:61], v[32:33] op_sel_hi:[1,0,1]
    v_pk_fma_f32 v[34:35], v[30:31], v[60:61], v[34:35] op_sel_hi:[1,0,1]
    v_cvt_pk_bf16_f32 v36, v32, v33
    v_cvt_pk_bf16_f32 v37, v34, v35
    ds_write_b64 v4, v[36:37]
    s_waitcnt lgkmcnt(0)
    s_barrier
    ds_read_b128 v[16:19], v5 offset:20992
    ds_read_b128 a[32:35], v6 offset:23296
    ds_read_b128 v[20:23], v5 offset:21056
    ds_read_b128 a[36:39], v6 offset:28416
    ds_read_b128 v[24:27], v5 offset:21120
    ds_read_b128 a[40:43], v6 offset:33536
    ds_read_b128 v[28:31], v5 offset:21184
    ds_read_b128 a[44:47], v6 offset:38656
    s_waitcnt lgkmcnt(6)
    v_mfma_f32_16x16x32_bf16 v[32:35], v[16:19], a[32:35], 0
    s_waitcnt lgkmcnt(4)
    v_mfma_f32_16x16x32_bf16 v[32:35], v[20:23], a[36:39], v[32:35]
    s_waitcnt lgkmcnt(2)
    v_mfma_f32_16x16x32_bf16 v[32:35], v[24:27], a[40:43], v[32:35]
    s_waitcnt lgkmcnt(0)
    v_mfma_f32_16x16x32_bf16 v[32:35], v[28:31], a[44:47], v[32:35]
    s_nop 7
    v_perm_b32 v36, v32, v3, s22
    v_perm_b32 v37, v33, v3, s23
    v_perm_b32 v38, v34, v3, s24
    v_perm_b32 v39, v35, v3, s25
    v_accvgpr_write_b32 a96, v36
    v_accvgpr_write_b32 a97, v37
    v_accvgpr_write_b32 a98, v38
    v_accvgpr_write_b32 a99, v39
    s_xor_b32 s14, s95, 151552
    s_waitcnt vmcnt(9)
    s_cbranch_vccnz L_loose151
    s_waitcnt vmcnt(5)
L_loose151:
    buffer_load_dwordx4 v[216:219], v2, s[44:47], s14 offen offset:0 nt
    v_cmp_le_u32 vcc, 48, v1
    s_nop 0
    s_bcnt1_i32_b32 vcc_hi, vcc_lo
    s_cmp_ge_u32 vcc_hi, s99
    s_cselect_b64 vcc, -1, 0
    v_perm_b32 v16, v164, v160, s16
    v_perm_b32 v20, v164, v160, s17
    v_perm_b32 v24, v165, v161, s16
    v_perm_b32 v28, v165, v161, s17
    v_perm_b32 v32, v166, v162, s16
    v_perm_b32 v36, v166, v162, s17
    v_perm_b32 v40, v167, v163, s16
    v_perm_b32 v44, v167, v163, s17
    v_perm_b32 v17, v172, v168, s16
    v_perm_b32 v21, v172, v168, s17
    v_perm_b32 v25, v173, v169, s16
    v_perm_b32 v29, v173, v169, s17
    v_perm_b32 v33, v174, v170, s16
    v_perm_b32 v37, v174, v170, s17
    v_perm_b32 v41, v175, v171, s16
    v_perm_b32 v45, v175, v171, s17
    v_perm_b32 v18, v180, v176, s16
    v_perm_b32 v22, v180, v176, s17
    v_perm_b32 v26, v181, v177, s16
    v_perm_b32 v30, v181, v177, s17
    v_perm_b32 v34, v182, v178, s16
    v_perm_b32 v38, v182, v178, s17
    v_perm_b32 v42, v183, v179, s16
    v_perm_b32 v46, v183, v179, s17
    s_waitcnt vmcnt(9)
    s_cbranch_vccnz L_loose152
    s_waitcnt vmcnt(5)
L_loose152:
    buffer_load_dwordx4 v[220:223], v2, s[44:47], s14 offen offset:2048 nt
    s_waitcnt vmcnt(8)
    v_mov_b32 v1, 56
    s_mov_b64 exec, 1
    buffer_store_byte v1, off, s[60:63], s97
    s_mov_b64 exec, -1
    buffer_load_ubyte v1, v0, s[60:63], s96 offen nt
    s_mov_b32 s4, 1050624
    buffer_load_dwordx4 v[64:67], off, s[60:63], s4 sc1
    buffer_load_dwordx4 v[48:51], v12, s[60:63], s28 offen offset:0
    buffer_load_dwordx4 v[52:55], v12, s[60:63], s28 offen offset:16
    buffer_load_dwordx4 v[56:59], v12, s[60:63], s28 offen offset:32
    buffer_load_dwordx4 v[60:63], v12, s[60:63], s28 offen offset:48
    v_perm_b32 v19, v188, v184, s16
    v_perm_b32 v23, v188, v184, s17
    v_perm_b32 v27, v189, v185, s16
    v_perm_b32 v31, v189, v185, s17
    v_perm_b32 v35, v190, v186, s16
    v_perm_b32 v39, v190, v186, s17
    v_perm_b32 v43, v191, v187, s16
    v_perm_b32 v47, v191, v187, s17
    v_mfma_f32_16x16x32_bf16 v[96:99], v[16:19], v[76:79], v[96:99]
    v_mfma_f32_16x16x32_bf16 v[100:103], v[20:23], v[76:79], v[100:103]
    v_mfma_f32_16x16x32_bf16 v[104:107], v[24:27], v[76:79], v[104:107]
    v_mfma_f32_16x16x32_bf16 v[108:111], v[28:31], v[76:79], v[108:111]
    v_mfma_f32_16x16x32_bf16 v[112:115], v[32:35], v[76:79], v[112:115]
    v_mfma_f32_16x16x32_bf16 v[116:119], v[36:39], v[76:79], v[116:119]
    v_mfma_f32_16x16x32_bf16 v[120:123], v[40:43], v[76:79], v[120:123]
    v_mfma_f32_16x16x32_bf16 v[124:127], v[44:47], v[76:79], v[124:127]
    s_xor_b32 s14, s95, 540672
    s_waitcnt vmcnt(14)
    s_cbranch_vccnz L_loose155
    s_waitcnt vmcnt(12)
L_loose155:
    buffer_load_dwordx4 v[224:227], v2, s[44:47], s14 offen offset:0 nt
    s_waitcnt vmcnt(14)
    s_cbranch_vccnz L_loose156
    s_waitcnt vmcnt(12)
L_loose156:
    buffer_load_dwordx4 v[228:231], v2, s[44:47], s14 offen offset:2048 nt
    v_perm_b32 v16, v196, v192, s16
    v_perm_b32 v20, v196, v192, s17
    v_perm_b32 v24, v197, v193, s16
    v_perm_b32 v28, v197, v193, s17
    v_perm_b32 v32, v198, v194, s16
    v_perm_b32 v36, v198, v194, s17
    v_perm_b32 v40, v199, v195, s16
    v_perm_b32 v44, v199, v195, s17
    s_xor_b32 s14, s95, 544768
    s_waitcnt vmcnt(14)
    s_cbranch_vccnz L_loose157
    s_waitcnt vmcnt(12)
L_loose157:
    buffer_load_dwordx4 v[232:235], v2, s[44:47], s14 offen offset:0 nt
    s_waitcnt vmcnt(14)
    s_cbranch_vccnz L_loose158
    s_waitcnt vmcnt(12)
L_loose158:
    buffer_load_dwordx4 v[236:239], v2, s[44:47], s14 offen offset:2048 nt
    v_perm_b32 v17, v204, v200, s16
    v_perm_b32 v21, v204, v200, s17
    v_perm_b32 v25, v205, v201, s16
    v_perm_b32 v29, v205, v201, s17
    v_perm_b32 v33, v206, v202, s16
    v_perm_b32 v37, v206, v202, s17
    v_perm_b32 v41, v207, v203, s16
    v_perm_b32 v45, v207, v203, s17
    s_xor_b32 s14, s95, 671744
    s_waitcnt vmcnt(14)
    s_cbranch_vccnz L_loose159
    s_waitcnt vmcnt(12)
L_loose159:
    buffer_load_dwordx4 v[240:243], v2, s[44:47], s14 offen offset:0 nt
    s_waitcnt vmcnt(14)
    s_cbranch_vccnz L_loose160
    s_waitcnt vmcnt(12)
L_loose160:
    buffer_load_dwordx4 v[244:247], v2, s[44:47], s14 offen offset:2048 nt
    v_perm_b32 v18, v212, v208, s16
    v_perm_b32 v22, v212, v208, s17
    v_perm_b32 v26, v213, v209, s16
    v_perm_b32 v30, v213, v209, s17
    v_perm_b32 v34, v214, v210, s16
    v_perm_b32 v38, v214, v210, s17
    v_perm_b32 v42, v215, v211, s16
    v_perm_b32 v46, v215, v211, s17
    s_xor_b32 s14, s95, 675840
    s_waitcnt vmcnt(14)
    s_cbranch_vccnz L_loose161
    s_waitcnt vmcnt(5)
L_loose161:
    buffer_load_dwordx4 v[248:251], v2, s[44:47], s14 offen offset:0 nt
    v_cmp_le_u32 vcc, 56, v1
    s_nop 0
    s_bcnt1_i32_b32 vcc_hi, vcc_lo
    s_cmp_ge_u32 vcc_hi, s99
    s_cselect_b64 vcc, -1, 0
    s_waitcnt vmcnt(14)
    s_cbranch_vccnz L_loose162
    s_waitcnt vmcnt(5)
L_loose162:
    buffer_load_dwordx4 v[252:255], v2, s[44:47], s14 offen offset:2048 nt
    s_waitcnt vmcnt(13)
    v_mov_b32 v1, 64
    s_mov_b64 exec, 1
    buffer_store_byte v1, off, s[60:63], s97
    s_mov_b64 exec, -1
    buffer_load_ubyte v1, v0, s[60:63], s96 offen nt
    v_perm_b32 v19, v220, v216, s16
    v_perm_b32 v23, v220, v216, s17
    v_perm_b32 v27, v221, v217, s16
    v_perm_b32 v31, v221, v217, s17
    v_perm_b32 v35, v222, v218, s16
    v_perm_b32 v39, v222, v218, s17
    v_perm_b32 v43, v223, v219, s16
    v_perm_b32 v47, v223, v219, s17
    v_mfma_f32_16x16x32_bf16 v[96:99], v[16:19], v[80:83], v[96:99]
    v_mfma_f32_16x16x32_bf16 v[100:103], v[20:23], v[80:83], v[100:103]
    v_mfma_f32_16x16x32_bf16 v[104:107], v[24:27], v[80:83], v[104:107]
    v_mfma_f32_16x16x32_bf16 v[108:111], v[28:31], v[80:83], v[108:111]
    v_mfma_f32_16x16x32_bf16 v[112:115], v[32:35], v[80:83], v[112:115]
    v_mfma_f32_16x16x32_bf16 v[116:119], v[36:39], v[80:83], v[116:119]
    v_mfma_f32_16x16x32_bf16 v[120:123], v[40:43], v[80:83], v[120:123]
    v_mfma_f32_16x16x32_bf16 v[124:127], v[44:47], v[80:83], v[124:127]
    s_xor_b32 s14, s95, 278528
    s_waitcnt vmcnt(9)
    s_cbranch_vccnz L_loose164
    s_waitcnt vmcnt(7)
L_loose164:
    buffer_load_dwordx4 v[128:131], v2, s[44:47], s14 offen offset:0 nt
    s_mov_b32 s98, vcc_lo
L_chk_ml:
    v_bitop3_b32 v16, v48, v52, s19 bitop3:0x7e
    v_bitop3_b32 v17, v49, v53, s20 bitop3:0x7e
    v_bitop3_b32 v18, v50, v54, s21 bitop3:0x7e
    v_or3_b32 v16, v16, v17, v18
    v_bitop3_b32 v17, v51, v55, s18 bitop3:0x7e
    v_bitop3_b32 v18, v56, v60, s19 bitop3:0x7e
    v_or3_b32 v16, v16, v17, v18
    v_bitop3_b32 v17, v57, v61, s20 bitop3:0x7e
    v_bitop3_b32 v18, v58, v62, s21 bitop3:0x7e
    v_or3_b32 v16, v16, v17, v18
    v_bitop3_b32 v17, v59, v63, s18 bitop3:0x7e
    v_bitop3_b32 v18, v64, v64, s19 bitop3:0x7e
    v_or3_b32 v16, v16, v17, v18
    v_bitop3_b32 v17, v65, v65, s20 bitop3:0x7e
    v_bitop3_b32 v18, v66, v66, s21 bitop3:0x7e
    v_or3_b32 v16, v16, v17, v18
    v_bitop3_b32 v17, v67, v67, s18 bitop3:0x7e
    v_bitop3_b32 v16, v16, v17, s93 bitop3:0x54
    v_cmp_ne_u32 vcc, 0, v16
    s_nop 0
    s_cbranch_vccnz L_retry_ml
L_ok_ml:
    s_mov_b32 vcc_lo, s98
    s_mov_b32 vcc_hi, s98
    s_waitcnt vmcnt(9)
    s_cbranch_vccnz L_loose165
    s_waitcnt vmcnt(7)
L_loose165:
    buffer_load_dwordx4 v[132:135], v2, s[44:47], s14 offen offset:2048 nt
    v_lshlrev_b32 v12, 4, v0
    v_readfirstlane_b32 s8, v64
    s_nop 0
    s_bfe_u32 s10, s8, 0x3000c
    s_and_b32 s15, s2, 3
    s_add_u32 s15, s15, s10
    s_xor_b32 s10, s10, s15
    s_lshl_b32 s10, s10, 6
    s_xor_b32 s8, s8, s10
    s_and_b32 s8, s8, 0x100
    s_lshl_b32 s10, s8, 5
    v_xor_b32 v8, s10, v8
    s_lshl_b32 s10, s8, 1
    v_xor_b32 v9, s10, v9
    v_mov_b32 v64, v3
    v_mov_b32 v68, v3
    v_mov_b32 v72, v3
    v_mov_b32 v76, v3
    s_cmp_eq_u32 s101, 0
    s_cselect_b32 s15, 63, 0
    v_and_b32 v48, s93, v48
    v_and_b32 v49, s93, v49
    v_and_b32 v50, s93, v50
    v_add_f32 v48, v48, v49
    v_and_b32 v52, s93, v52
    s_xor_b32 s14, s95, 282624
    s_waitcnt vmcnt(9)
    s_cbranch_vccnz L_loose166
    s_waitcnt vmcnt(7)
L_loose166:
    buffer_load_dwordx4 v[136:139], v2, s[44:47], s14 offen offset:0 nt
    v_and_b32 v53, s93, v53
    v_and_b32 v54, s93, v54
    v_add_f32 v52, v52, v53
    v_and_b32 v56, s93, v56
    v_and_b32 v57, s93, v57
    v_and_b32 v58, s93, v58
    v_add_f32 v56, v56, v57
    v_and_b32 v60, s93, v60
    v_and_b32 v61, s93, v61
    v_and_b32 v62, s93, v62
    v_add_f32 v60, v60, v61
    v_max3_f32 v16, v48, v52, v56
    v_max_f32 v16, v16, v60
    v_sub_f32 v48, v48, v16
    v_sub_f32 v52, v52, v16
    v_sub_f32 v56, v56, v16
    v_sub_f32 v60, v60, v16
    v_exp_f32 v48, v48
    v_exp_f32 v52, v52
    v_exp_f32 v56, v56
    v_exp_f32 v60, v60
    v_mul_f32 v16, v48, v50
    v_fmac_f32 v16, v52, v54
    v_fmac_f32 v16, v56, v58
    s_waitcnt vmcnt(9)
    s_cbranch_vccnz L_loose167
    s_waitcnt vmcnt(7)
L_loose167:
    buffer_load_dwordx4 v[140:143], v2, s[44:47], s14 offen offset:2048 nt
    v_fmac_f32 v16, v60, v62
    v_rcp_f32 v16, v16
    s_nop 0
    v_mul_f32 v48, v48, v16
    v_mul_f32 v52, v52, v16
    v_mul_f32 v56, v56, v16
    v_mul_f32 v60, v60, v16
    v_perm_b32 v16, v228, v224, s16
    v_perm_b32 v20, v228, v224, s17
    v_perm_b32 v24, v229, v225, s16
    v_perm_b32 v28, v229, v225, s17
    v_perm_b32 v32, v230, v226, s16
    v_perm_b32 v36, v230, v226, s17
    v_perm_b32 v40, v231, v227, s16
    v_perm_b32 v44, v231, v227, s17
    v_perm_b32 v17, v236, v232, s16
    v_perm_b32 v21, v236, v232, s17
    v_perm_b32 v25, v237, v233, s16
    v_perm_b32 v29, v237, v233, s17
    v_perm_b32 v33, v238, v234, s16
    v_perm_b32 v37, v238, v234, s17
    v_perm_b32 v41, v239, v235, s16
    v_perm_b32 v45, v239, v235, s17
    s_xor_b32 s14, s95, 409600
    s_waitcnt vmcnt(9)
    s_cbranch_vccnz L_loose168
    s_waitcnt vmcnt(7)
L_loose168:
    buffer_load_dwordx4 v[144:147], v2, s[44:47], s14 offen offset:0 nt
    s_waitcnt vmcnt(9)
    s_cbranch_vccnz L_loose169
    s_waitcnt vmcnt(7)
L_loose169:
    buffer_load_dwordx4 v[148:151], v2, s[44:47], s14 offen offset:2048 nt
    v_perm_b32 v18, v244, v240, s16
    v_perm_b32 v22, v244, v240, s17
    v_perm_b32 v26, v245, v241, s16
    v_perm_b32 v30, v245, v241, s17
    v_perm_b32 v34, v246, v242, s16
    v_perm_b32 v38, v246, v242, s17
    v_perm_b32 v42, v247, v243, s16
    v_perm_b32 v46, v247, v243, s17
    s_xor_b32 s14, s95, 413696
    s_waitcnt vmcnt(9)
    s_cbranch_vccnz L_loose170
    s_waitcnt vmcnt(5)
L_loose170:
    buffer_load_dwordx4 v[152:155], v2, s[44:47], s14 offen offset:0 nt
    v_cmp_le_u32 vcc, 64, v1
    s_nop 0
    s_bcnt1_i32_b32 vcc_hi, vcc_lo
    s_cmp_ge_u32 vcc_hi, s99
    s_cselect_b64 vcc, -1, 0
    s_waitcnt vmcnt(9)
    s_cbranch_vccnz L_loose171
    s_waitcnt vmcnt(5)
L_loose171:
    buffer_load_dwordx4 v[156:159], v2, s[44:47], s14 offen offset:2048 nt
    s_waitcnt vmcnt(8)
    v_mov_b32 v1, 72
    s_mov_b64 exec, 1
    buffer_store_byte v1, off, s[60:63], s97
    s_mov_b64 exec, -1
    buffer_load_ubyte v1, v0, s[60:63], s96 offen nt
    v_perm_b32 v19, v252, v248, s16
    v_perm_b32 v23, v252, v248, s17
    v_perm_b32 v27, v253, v249, s16
    v_perm_b32 v31, v253, v249, s17
    v_perm_b32 v35, v254, v250, s16
    v_perm_b32 v39, v254, v250, s17
    v_perm_b32 v43, v255, v251, s16
    v_perm_b32 v47, v255, v251, s17
    v_mfma_f32_16x16x32_bf16 v[96:99], v[16:19], v[84:87], v[96:99]
    v_mfma_f32_16x16x32_bf16 v[100:103], v[20:23], v[84:87], v[100:103]
    v_mfma_f32_16x16x32_bf16 v[104:107], v[24:27], v[84:87], v[104:107]
    v_mfma_f32_16x16x32_bf16 v[108:111], v[28:31], v[84:87], v[108:111]
    v_mfma_f32_16x16x32_bf16 v[112:115], v[32:35], v[84:87], v[112:115]
    v_mfma_f32_16x16x32_bf16 v[116:119], v[36:39], v[84:87], v[116:119]
    v_mfma_f32_16x16x32_bf16 v[120:123], v[40:43], v[84:87], v[120:123]
    v_mfma_f32_16x16x32_bf16 v[124:127], v[44:47], v[84:87], v[124:127]
    s_xor_b32 s14, s95, 802816
    s_waitcnt vmcnt(9)
    s_cbranch_vccnz L_loose173
    s_waitcnt vmcnt(7)
L_loose173:
    buffer_load_dwordx4 v[160:163], v2, s[44:47], s14 offen offset:0 nt
    s_waitcnt vmcnt(9)
    s_cbranch_vccnz L_loose174
    s_waitcnt vmcnt(7)
L_loose174:
    buffer_load_dwordx4 v[164:167], v2, s[44:47], s14 offen offset:2048 nt
    s_cmp_lg_u32 s3, 0
    s_cbranch_scc1 L_nowarm
    buffer_load_ushort a1, v9, s[64:67], 0 offen
    s_cmp_eq_u32 s5, 0
    s_cbranch_scc1 L_nowarm
    buffer_load_dwordx4 a[80:83], v8, s[60:63], 0 offen sc1
    buffer_load_dwordx4 a[84:87], v8, s[60:63], s28 offen sc1
    buffer_load_dwordx4 a[88:91], v8, s[60:63], s29 offen sc1
    buffer_load_dwordx4 a[92:95], v8, s[60:63], s30 offen sc1
L_nowarm:
    v_perm_b32 v16, v132, v128, s16
    v_perm_b32 v20, v132, v128, s17
    v_perm_b32 v24, v133, v129, s16
    v_perm_b32 v28, v133, v129, s17
    v_perm_b32 v32, v134, v130, s16
    v_perm_b32 v36, v134, v130, s17
    v_perm_b32 v40, v135, v131, s16
    v_perm_b32 v44, v135, v131, s17
    s_xor_b32 s14, s95, 806912
    s_waitcnt vmcnt(9)
    s_cbranch_vccnz L_loose176
    s_waitcnt vmcnt(7)
L_loose176:
    buffer_load_dwordx4 v[168:171], v2, s[44:47], s14 offen offset:0 nt
    s_waitcnt vmcnt(9)
    s_cbranch_vccnz L_loose177
    s_waitcnt vmcnt(7)
L_loose177:
    buffer_load_dwordx4 v[172:175], v2, s[44:47], s14 offen offset:2048 nt
    v_perm_b32 v17, v140, v136, s16
    v_perm_b32 v21, v140, v136, s17
    v_perm_b32 v25, v141, v137, s16
    v_perm_b32 v29, v141, v137, s17
    v_perm_b32 v33, v142, v138, s16
    v_perm_b32 v37, v142, v138, s17
    v_perm_b32 v41, v143, v139, s16
    v_perm_b32 v45, v143, v139, s17
    s_xor_b32 s14, s95, 933888
    s_waitcnt vmcnt(9)
    s_cbranch_vccnz L_loose178
    s_waitcnt vmcnt(7)
L_loose178:
    buffer_load_dwordx4 v[176:179], v2, s[44:47], s14 offen offset:0 nt
    s_waitcnt vmcnt(9)
    s_cbranch_vccnz L_loose179
    s_waitcnt vmcnt(7)
L_loose179:
    buffer_load_dwordx4 v[180:183], v2, s[44:47], s14 offen offset:2048 nt
    v_perm_b32 v18, v148, v144, s16
    v_perm_b32 v22, v148, v144, s17
    v_perm_b32 v26, v149, v145, s16
    v_perm_b32 v30, v149, v145, s17
    v_perm_b32 v34, v150, v146, s16
    v_perm_b32 v38, v150, v146, s17
    v_perm_b32 v42, v151, v147, s16
    v_perm_b32 v46, v151, v147, s17
    s_xor_b32 s14, s95, 937984
    s_waitcnt vmcnt(9)
    s_cbranch_vccnz L_loose180
    s_waitcnt vmcnt(5)
L_loose180:
    buffer_load_dwordx4 v[184:187], v2, s[44:47], s14 offen offset:0 nt
    v_cmp_le_u32 vcc, 72, v1
    s_nop 0
    s_bcnt1_i32_b32 vcc_hi, vcc_lo
    s_cmp_ge_u32 vcc_hi, s99
    s_cselect_b64 vcc, -1, 0
    s_waitcnt vmcnt(9)
    s_cbranch_vccnz L_loose181
    s_waitcnt vmcnt(5)
L_loose181:
    buffer_load_dwordx4 v[188:191], v2, s[44:47], s14 offen offset:2048 nt
    v_perm_b32 v19, v156, v152, s16
    v_perm_b32 v23, v156, v152, s17
    v_perm_b32 v27, v157, v153, s16
    v_perm_b32 v31, v157, v153, s17
    v_perm_b32 v35, v158, v154, s16
    v_perm_b32 v39, v158, v154, s17
    v_perm_b32 v43, v159, v155, s16
    v_perm_b32 v47, v159, v155, s17
    v_mfma_f32_16x16x32_bf16 v[96:99], v[16:19], v[88:91], v[96:99]
    v_mfma_f32_16x16x32_bf16 v[100:103], v[20:23], v[88:91], v[100:103]
    v_mfma_f32_16x16x32_bf16 v[104:107], v[24:27], v[88:91], v[104:107]
    v_mfma_f32_16x16x32_bf16 v[108:111], v[28:31], v[88:91], v[108:111]
    v_mfma_f32_16x16x32_bf16 v[112:115], v[32:35], v[88:91], v[112:115]
    v_mfma_f32_16x16x32_bf16 v[116:119], v[36:39], v[88:91], v[116:119]
    v_mfma_f32_16x16x32_bf16 v[120:123], v[40:43], v[88:91], v[120:123]
    v_mfma_f32_16x16x32_bf16 v[124:127], v[44:47], v[88:91], v[124:127]
    s_mov_b32 s4, 0
    s_waitcnt vmcnt(7)
    s_cbranch_vccnz L_loose182
    s_waitcnt vmcnt(5)
L_loose182:
    buffer_load_dwordx4 v[224:227], v15, s[48:51], s4 offen nt
    s_mov_b32 s4, 8192
    s_waitcnt vmcnt(7)
    s_cbranch_vccnz L_loose183
    s_waitcnt vmcnt(5)
L_loose183:
    buffer_load_dwordx4 v[228:231], v15, s[48:51], s4 offen nt
    v_perm_b32 v16, v164, v160, s16
    v_perm_b32 v20, v164, v160, s17
    v_perm_b32 v24, v165, v161, s16
    v_perm_b32 v28, v165, v161, s17
    v_perm_b32 v32, v166, v162, s16
    v_perm_b32 v36, v166, v162, s17
    v_perm_b32 v40, v167, v163, s16
    v_perm_b32 v44, v167, v163, s17
    s_mov_b32 s4, 16384
    s_waitcnt vmcnt(7)
    s_cbranch_vccnz L_loose184
    s_waitcnt vmcnt(5)
L_loose184:
    buffer_load_dwordx4 v[232:235], v15, s[48:51], s4 offen nt
    s_mov_b32 s4, 24576
    s_waitcnt vmcnt(7)
    s_cbranch_vccnz L_loose185
    s_waitcnt vmcnt(5)
L_loose185:
    buffer_load_dwordx4 v[236:239], v15, s[48:51], s4 offen nt
    v_perm_b32 v17, v172, v168, s16
    v_perm_b32 v21, v172, v168, s17
    v_perm_b32 v25, v173, v169, s16
    v_perm_b32 v29, v173, v169, s17
    v_perm_b32 v33, v174, v170, s16
    v_perm_b32 v37, v174, v170, s17
    v_perm_b32 v41, v175, v171, s16
    v_perm_b32 v45, v175, v171, s17
    s_waitcnt vmcnt(6)
    v_perm_b32 v18, v180, v176, s16
    v_perm_b32 v22, v180, v176, s17
    v_perm_b32 v26, v181, v177, s16
    v_perm_b32 v30, v181, v177, s17
    v_perm_b32 v34, v182, v178, s16
    v_perm_b32 v38, v182, v178, s17
    v_perm_b32 v42, v183, v179, s16
    v_perm_b32 v46, v183, v179, s17
    s_waitcnt vmcnt(4)
    v_perm_b32 v19, v188, v184, s16
    v_perm_b32 v23, v188, v184, s17
    v_perm_b32 v27, v189, v185, s16
    v_perm_b32 v31, v189, v185, s17
    v_perm_b32 v35, v190, v186, s16
    v_perm_b32 v39, v190, v186, s17
    v_perm_b32 v43, v191, v187, s16
    v_perm_b32 v47, v191, v187, s17
    v_mfma_f32_16x16x32_bf16 v[96:99], v[16:19], v[92:95], v[96:99]
    v_mfma_f32_16x16x32_bf16 v[100:103], v[20:23], v[92:95], v[100:103]
    v_mfma_f32_16x16x32_bf16 v[104:107], v[24:27], v[92:95], v[104:107]
    v_mfma_f32_16x16x32_bf16 v[108:111], v[28:31], v[92:95], v[108:111]
    v_mfma_f32_16x16x32_bf16 v[112:115], v[32:35], v[92:95], v[112:115]
    v_mfma_f32_16x16x32_bf16 v[116:119], v[36:39], v[92:95], v[116:119]
    v_mfma_f32_16x16x32_bf16 v[120:123], v[40:43], v[92:95], v[120:123]
    v_mfma_f32_16x16x32_bf16 v[124:127], v[44:47], v[92:95], v[124:127]
    s_mov_b64 exec, s[68:69]
    ds_write_b128 v10, v[96:99] offset:8960
    ds_write_b128 v10, v[100:103] offset:8976
    ds_write_b128 v10, v[104:107] offset:8992
    ds_write_b128 v10, v[108:111] offset:9008
    ds_write_b128 v10, v[112:115] offset:9024
    ds_write_b128 v10, v[116:119] offset:9040
    ds_write_b128 v10, v[120:123] offset:9056
    ds_write_b128 v10, v[124:127] offset:9072
    s_mov_b32 exec_lo, -1
    s_mov_b32 exec_hi, 0
    s_cmp_lg_u32 s101, 0
    buffer_store_dwordx4 a[96:99], v12, s[60:63], s70 offen sc1
    s_waitcnt lgkmcnt(0)
    s_barrier
    ds_read_b128 v[16:19], v11 offset:8960
    ds_read_b128 v[20:23], v11 offset:11200
    ds_read_b128 v[24:27], v11 offset:13440
    ds_read_b128 v[28:31], v11 offset:15680
    s_waitcnt lgkmcnt(0)
    v_pk_add_f32 v[32:33], v[16:17], v[20:21]
    v_pk_add_f32 v[34:35], v[18:19], v[22:23]
    v_pk_add_f32 v[36:37], v[24:25], v[28:29]
    v_pk_add_f32 v[38:39], v[26:27], v[30:31]
    v_pk_add_f32 v[32:33], v[32:33], v[36:37]
    v_pk_add_f32 v[34:35], v[34:35], v[38:39]
    v_perm_b32 v40, v32, v3, s23
    v_perm_b32 v41, v33, v3, s24
    v_perm_b32 v42, v34, v3, s25
    v_perm_b32 v43, v35, v3, s22
    s_cbranch_scc1 L_far_st1
    buffer_store_dwordx4 v[40:43], v7, s[60:63], s31 offen
L_st_done1:
    s_mov_b64 exec, -1
    buffer_load_dwordx4 v[64:67], v13, s[60:63], s31 offen offset:0 nt
    buffer_load_dwordx4 v[68:71], v13, s[60:63], s31 offen offset:512 nt
    buffer_load_dwordx4 v[72:75], v13, s[60:63], s31 offen offset:1024 nt
    buffer_load_dwordx4 v[76:79], v13, s[60:63], s31 offen offset:1536 nt
    s_waitcnt vmcnt(6)
    v_perm_b32 v240, v228, v224, s16
    v_perm_b32 v241, v236, v232, s16
    ds_write_b64 v14, v[240:241] offset:43776
    v_perm_b32 v242, v228, v224, s17
    v_perm_b32 v243, v236, v232, s17
    ds_write_b64 v14, v[242:243] offset:44416
    v_perm_b32 v244, v229, v225, s16
    v_perm_b32 v245, v237, v233, s16
    ds_write_b64 v14, v[244:245] offset:45056
    v_perm_b32 v246, v229, v225, s17
    v_perm_b32 v247, v237, v233, s17
    ds_write_b64 v14, v[246:247] offset:45696
    v_perm_b32 v248, v230, v226, s16
    v_perm_b32 v249, v238, v234, s16
    ds_write_b64 v14, v[248:249] offset:46336
    v_perm_b32 v250, v230, v226, s17
    v_perm_b32 v251, v238, v234, s17
    ds_write_b64 v14, v[250:251] offset:46976
    v_perm_b32 v252, v231, v227, s16
    v_perm_b32 v253, v239, v235, s16
    ds_write_b64 v14, v[252:253] offset:47616
    v_perm_b32 v254, v231, v227, s17
    v_perm_b32 v255, v239, v235, s17
    ds_write_b64 v14, v[254:255] offset:48256
    s_waitcnt lgkmcnt(0)
    s_barrier
    ds_read_b128 a[32:35], v6 offset:43776
    ds_read_b128 a[36:39], v6 offset:48896
    ds_read_b128 a[40:43], v6 offset:54016
    ds_read_b128 a[44:47], v6 offset:59136
    s_branch L_chk_o1
L_retry_o1:
    s_mov_b64 exec, vcc
    s_cmp_eq_u32 s27, 0
    s_cbranch_scc1 L_ok_o1
    s_sub_u32 s27, s27, 1
    s_and_b32 s8, s27, s15
    s_cbranch_scc0 L_far_o1
L_poll_o1:
    buffer_load_dwordx4 v[64:67], v13, s[60:63], s31 offen offset:0 nt
    buffer_load_dwordx4 v[68:71], v13, s[60:63], s31 offen offset:512 nt
    buffer_load_dwordx4 v[72:75], v13, s[60:63], s31 offen offset:1024 nt
    buffer_load_dwordx4 v[76:79], v13, s[60:63], s31 offen offset:1536 nt
    s_waitcnt vmcnt(4)
L_chk_o1:
    v_bitop3_b32 v80, v64, v68, s19 bitop3:0x7e
    v_bitop3_b32 v81, v65, v69, s20 bitop3:0x7e
    v_bitop3_b32 v82, v66, v70, s21 bitop3:0x7e
    v_or3_b32 v80, v80, v81, v82
    v_bitop3_b32 v81, v67, v71, s18 bitop3:0x7e
    v_bitop3_b32 v82, v72, v76, s19 bitop3:0x7e
    v_or3_b32 v80, v80, v81, v82
    v_bitop3_b32 v81, v73, v77, s20 bitop3:0x7e
    v_bitop3_b32 v82, v74, v78, s21 bitop3:0x7e
    v_or3_b32 v80, v80, v81, v82
    v_bitop3_b32 v81, v75, v79, s18 bitop3:0x7e
    v_bitop3_b32 v80, v80, v81, s93 bitop3:0x54
    v_cmp_ne_u32 vcc, 0, v80
    s_nop 0
    s_cbranch_vccnz L_retry_o1
L_ok_o1:
    s_mov_b64 exec, -1
    v_and_b32 v96, s93, v64
    v_and_b32 v97, s93, v65
    v_and_b32 v98, s93, v66
    v_and_b32 v99, s93, v67
    v_and_b32 v100, s93, v68
    v_and_b32 v101, s93, v69
    v_and_b32 v102, s93, v70
    v_and_b32 v103, s93, v71
    v_and_b32 v104, s93, v72
    v_and_b32 v105, s93, v73
    v_and_b32 v106, s93, v74
    v_and_b32 v107, s93, v75
    v_and_b32 v108, s93, v76
    v_and_b32 v109, s93, v77
    v_and_b32 v110, s93, v78
    v_and_b32 v111, s93, v79
    v_pk_mul_f32 v[112:113], v[96:97], v[48:49] op_sel_hi:[1,0]
    v_pk_mul_f32 v[114:115], v[98:99], v[48:49] op_sel_hi:[1,0]
    v_pk_fma_f32 v[112:113], v[100:101], v[52:53], v[112:113] op_sel_hi:[1,0,1]
    v_pk_fma_f32 v[114:115], v[102:103], v[52:53], v[114:115] op_sel_hi:[1,0,1]
    v_pk_fma_f32 v[112:113], v[104:105], v[56:57], v[112:113] op_sel_hi:[1,0,1]
    v_pk_fma_f32 v[114:115], v[106:107], v[56:57], v[114:115] op_sel_hi:[1,0,1]
    v_pk_fma_f32 v[112:113], v[108:109], v[60:61], v[112:113] op_sel_hi:[1,0,1]
    v_pk_fma_f32 v[114:115], v[110:111], v[60:61], v[114:115] op_sel_hi:[1,0,1]
    v_cvt_pk_bf16_f32 v116, v112, v113
    v_cvt_pk_bf16_f32 v117, v114, v115
    ds_write_b64 v4, v[116:117]
    s_waitcnt lgkmcnt(0)
    s_barrier
    ds_read_b128 v[96:99], v5 offset:20992
    ds_read_b128 v[100:103], v5 offset:21056
    ds_read_b128 v[104:107], v5 offset:21120
    ds_read_b128 v[108:111], v5 offset:21184
    s_waitcnt lgkmcnt(3)
    v_mfma_f32_16x16x32_bf16 v[112:115], v[96:99], a[32:35], 0
    s_waitcnt lgkmcnt(2)
    v_mfma_f32_16x16x32_bf16 v[112:115], v[100:103], a[36:39], v[112:115]
    s_waitcnt lgkmcnt(1)
    v_mfma_f32_16x16x32_bf16 v[112:115], v[104:107], a[40:43], v[112:115]
    s_waitcnt lgkmcnt(0)
    v_mfma_f32_16x16x32_bf16 v[112:115], v[108:111], a[44:47], v[112:115]
    s_mov_b32 exec_hi, 0
    s_nop 6
    v_perm_b32 v116, v112, v3, s22
    v_perm_b32 v117, v113, v3, s23
    v_perm_b32 v118, v114, v3, s24
    v_perm_b32 v119, v115, v3, s25
    buffer_store_dwordx4 v[116:119], v12, s[60:63], s71 offen sc1
    s_mov_b32 exec_hi, -1
    s_cmp_lg_u32 s3, 0
    s_cbranch_scc1 L_fin
    v_not_b32 v128, v3
    v_not_b32 v132, v3
    v_not_b32 v136, v3
    v_not_b32 v140, v3
    s_cmp_eq_u32 s5, 0
    s_cbranch_scc1 L_poll_p2
    s_waitcnt vmcnt(0)
    s_branch L_poll_p2
L_retry_p2:
    s_mov_b64 exec, vcc
    s_cmp_eq_u32 s27, 0
    s_cbranch_scc1 L_ok_p2
    s_sub_u32 s27, s27, 1
L_poll_p2:
    buffer_load_dwordx4 v[128:131], v8, s[60:63], 0 offen sc1
    buffer_load_dwordx4 v[132:135], v8, s[60:63], s28 offen sc1
    buffer_load_dwordx4 v[136:139], v8, s[60:63], s29 offen sc1
    buffer_load_dwordx4 v[140:143], v8, s[60:63], s30 offen sc1
    s_waitcnt vmcnt(8)
L_chk_p2:
    v_bitop3_b32 v80, v128, v132, s18 bitop3:0x7e
    v_bitop3_b32 v81, v129, v133, s19 bitop3:0x7e
    v_bitop3_b32 v82, v130, v134, s20 bitop3:0x7e
    v_or3_b32 v80, v80, v81, v82
    v_bitop3_b32 v81, v131, v135, s21 bitop3:0x7e
    v_bitop3_b32 v82, v136, v140, s18 bitop3:0x7e
    v_or3_b32 v80, v80, v81, v82
    v_bitop3_b32 v81, v137, v141, s19 bitop3:0x7e
    v_bitop3_b32 v82, v138, v142, s20 bitop3:0x7e
    v_or3_b32 v80, v80, v81, v82
    v_bitop3_b32 v81, v139, v143, s21 bitop3:0x7e
    v_bitop3_b32 v80, v80, v81, s93 bitop3:0x54
    v_cmp_ne_u32 vcc, 0, v80
    s_nop 0
    s_cbranch_vccnz L_retry_p2
L_ok_p2:
    s_mov_b64 exec, -1
    v_and_b32 v152, s93, v128
    v_and_b32 v153, s93, v129
    v_and_b32 v154, s93, v130
    v_and_b32 v155, s93, v131
    v_and_b32 v156, s93, v132
    v_and_b32 v157, s93, v133
    v_and_b32 v158, s93, v134
    v_and_b32 v159, s93, v135
    v_and_b32 v160, s93, v136
    v_and_b32 v161, s93, v137
    v_and_b32 v162, s93, v138
    v_and_b32 v163, s93, v139
    v_and_b32 v164, s93, v140
    v_and_b32 v165, s93, v141
    v_and_b32 v166, s93, v142
    v_and_b32 v167, s93, v143
    v_pk_add_f32 v[144:145], v[152:153], v[156:157]
    v_pk_add_f32 v[146:147], v[154:155], v[158:159]
    v_pk_add_f32 v[148:149], v[160:161], v[164:165]
    v_pk_add_f32 v[150:151], v[162:163], v[166:167]
    v_pk_add_f32 v[144:145], v[144:145], v[148:149]
    v_pk_add_f32 v[146:147], v[146:147], v[150:151]
L_ok_pa:
    s_nop 1
    v_permlane32_swap_b32 v144, v146
    v_permlane32_swap_b32 v145, v147
    v_pk_add_f32 v[144:145], v[144:145], v[146:147]
    s_nop 1
    v_permlane16_swap_b32 v144, v145
    v_add_f32 v144, v144, v145
    s_nop 1
    v_add_f32_dpp v145, v144, v144 row_ror:8 row_mask:0xf bank_mask:0xf
    v_cvt_pk_bf16_f32 v145, v145, v145
    buffer_store_short v145, v9, s[64:67], 0 offen
    s_cmp_lg_u32 s2, 0
    s_cbranch_scc1 L_fin
    v_mov_b32 v4, 1048576
    v_mov_b32 v5, s92
    s_mov_b64 exec, 1
    buffer_store_dword v5, v4, s[60:63], 0 offen sc1
L_fin:
L_end:
    s_endpgm
L_decide:
    s_cmp_gt_i32 s98, 0
    s_cselect_b32 vcc_lo, 0, 0x100
    s_getreg_b32 vcc_hi, hwreg(HW_REG_XCC_ID, 0, 3)
    s_lshl_b32 vcc_hi, vcc_hi, 12
    s_or_b32 vcc_lo, vcc_lo, vcc_hi
    v_mov_b32 v56, vcc_lo
    v_perm_b32 v59, v56, v3, s22
    v_perm_b32 v58, v56, v3, s25
    v_perm_b32 v57, v56, v3, s24
    v_perm_b32 v56, v56, v3, s23
    v_mov_b32 v60, 1050624
    s_mov_b64 exec, 1
    buffer_store_dwordx4 v[56:59], v60, s[60:63], 0 offen sc1
    s_mov_b64 exec, -1
    s_branch L_decided
L_retry_q:
    s_cmp_eq_u32 s27, 0
    s_cbranch_scc1 L_ok_q
    s_sub_u32 s27, s27, 1
    s_sleep 4
    s_and_b32 s8, s27, 3
    s_cbranch_scc0 L_q_far
L_q_near:
    buffer_load_dwordx4 v[128:131], v11, s[60:63], s6 offen offset:0 sc1
    buffer_load_dwordx4 v[132:135], v11, s[60:63], s6 offen offset:512 sc1
    buffer_load_dwordx4 v[136:139], v11, s[60:63], s6 offen offset:1024 sc1
    buffer_load_dwordx4 v[140:143], v11, s[60:63], s6 offen offset:1536 sc1
    s_waitcnt vmcnt(0)
    s_branch L_chk_q
L_q_far:
    s_add_u32 s8, s6, 0
    buffer_load_dwordx4 v[64:67], v17, s[60:63], s8 offen sc1
    s_add_u32 s8, s6, 4096
    buffer_load_dwordx4 v[68:71], v17, s[60:63], s8 offen sc1
    s_add_u32 s8, s6, 8192
    buffer_load_dwordx4 v[72:75], v17, s[60:63], s8 offen sc1
    s_add_u32 s8, s6, 12288
    buffer_load_dwordx4 v[76:79], v17, s[60:63], s8 offen sc1
    s_waitcnt vmcnt(0)
    v_bitop3_b32 v32, v64, v68, s18 bitop3:0x7e
    v_bitop3_b32 v33, v65, v69, s19 bitop3:0x7e
    v_bitop3_b32 v34, v66, v70, s20 bitop3:0x7e
    v_or3_b32 v32, v32, v33, v34
    v_bitop3_b32 v33, v67, v71, s21 bitop3:0x7e
    v_bitop3_b32 v34, v72, v76, s18 bitop3:0x7e
    v_or3_b32 v32, v32, v33, v34
    v_bitop3_b32 v33, v73, v77, s19 bitop3:0x7e
    v_bitop3_b32 v34, v74, v78, s20 bitop3:0x7e
    v_or3_b32 v32, v32, v33, v34
    v_bitop3_b32 v33, v75, v79, s21 bitop3:0x7e
    v_bitop3_b32 v32, v32, v33, s93 bitop3:0x54
    v_cmp_ne_u32 vcc, 0, v32
    s_nop 0
    s_cbranch_vccnz L_q_near
    s_mov_b32 s8, 0
    buffer_store_dwordx4 v[64:67], v17, s[60:63], s8 offen sc1
    s_mov_b32 s8, 4096
    buffer_store_dwordx4 v[68:71], v17, s[60:63], s8 offen sc1
    s_mov_b32 s8, 8192
    buffer_store_dwordx4 v[72:75], v17, s[60:63], s8 offen sc1
    s_mov_b32 s8, 12288
    buffer_store_dwordx4 v[76:79], v17, s[60:63], s8 offen sc1
    buffer_load_dwordx4 v[128:131], v11, s[60:63], 0 offen offset:0 sc1
    buffer_load_dwordx4 v[132:135], v11, s[60:63], 0 offen offset:512 sc1
    buffer_load_dwordx4 v[136:139], v11, s[60:63], 0 offen offset:1024 sc1
    buffer_load_dwordx4 v[140:143], v11, s[60:63], 0 offen offset:1536 sc1
    s_waitcnt vmcnt(0)
    v_bitop3_b32 v32, v128, v132, s18 bitop3:0x7e
    v_bitop3_b32 v33, v129, v133, s19 bitop3:0x7e
    v_bitop3_b32 v34, v130, v134, s20 bitop3:0x7e
    v_or3_b32 v32, v32, v33, v34
    v_bitop3_b32 v33, v131, v135, s21 bitop3:0x7e
    v_bitop3_b32 v34, v136, v140, s18 bitop3:0x7e
    v_or3_b32 v32, v32, v33, v34
    v_bitop3_b32 v33, v137, v141, s19 bitop3:0x7e
    v_bitop3_b32 v34, v138, v142, s20 bitop3:0x7e
    v_or3_b32 v32, v32, v33, v34
    v_bitop3_b32 v33, v139, v143, s21 bitop3:0x7e
    v_bitop3_b32 v32, v32, v33, s93 bitop3:0x54
    v_cmp_ne_u32 vcc, 0, v32
    s_nop 0
    s_cbranch_vccnz L_q_near
    buffer_load_dwordx4 v[128:131], v11, s[60:63], s6 offen offset:0 sc1
    buffer_load_dwordx4 v[132:135], v11, s[60:63], s6 offen offset:512 sc1
    buffer_load_dwordx4 v[136:139], v11, s[60:63], s6 offen offset:1024 sc1
    buffer_load_dwordx4 v[140:143], v11, s[60:63], s6 offen offset:1536 sc1
    s_waitcnt vmcnt(0)
    v_bitop3_b32 v32, v128, v132, s18 bitop3:0x7e
    v_bitop3_b32 v33, v129, v133, s19 bitop3:0x7e
    v_bitop3_b32 v34, v130, v134, s20 bitop3:0x7e
    v_or3_b32 v32, v32, v33, v34
    v_bitop3_b32 v33, v131, v135, s21 bitop3:0x7e
    v_bitop3_b32 v34, v136, v140, s18 bitop3:0x7e
    v_or3_b32 v32, v32, v33, v34
    v_bitop3_b32 v33, v137, v141, s19 bitop3:0x7e
    v_bitop3_b32 v34, v138, v142, s20 bitop3:0x7e
    v_or3_b32 v32, v32, v33, v34
    v_bitop3_b32 v33, v139, v143, s21 bitop3:0x7e
    v_bitop3_b32 v32, v32, v33, s93 bitop3:0x54
    v_cmp_ne_u32 vcc, 0, v32
    s_nop 0
    s_cbranch_vccz L_ok_q
    s_mov_b32 s101, 1
    buffer_load_dwordx4 v[128:131], v11, s[60:63], 0 offen offset:0 sc1
    buffer_load_dwordx4 v[132:135], v11, s[60:63], 0 offen offset:512 sc1
    buffer_load_dwordx4 v[136:139], v11, s[60:63], 0 offen offset:1024 sc1
    buffer_load_dwordx4 v[140:143], v11, s[60:63], 0 offen offset:1536 sc1
    s_waitcnt vmcnt(0)
    s_branch L_ok_q
L_retry_sib:
    s_cmp_eq_u32 s27, 0
    s_cbranch_scc1 L_ok_sib
    s_sub_u32 s27, s27, 1
    s_sleep 4
    buffer_load_dwordx4 v[16:19], off, s[60:63], s7 sc1
    s_waitcnt vmcnt(0)
    s_branch L_chk_sib
L_far_st0:
    buffer_store_dwordx4 v[40:43], v7, s[60:63], 0 offen sc1
    s_branch L_st_done0
L_retry_a1:
    s_cmp_eq_u32 s27, 0
    s_cbranch_scc1 L_ok_a1
    s_sub_u32 s27, s27, 1
    s_sleep 4
    buffer_load_dwordx4 v[48:51], v12, s[60:63], 0 offen offset:0 sc1
    buffer_load_dwordx4 v[52:55], v12, s[60:63], 0 offen offset:16 sc1
    buffer_load_dwordx4 v[56:59], v12, s[60:63], 0 offen offset:32 sc1
    buffer_load_dwordx4 v[60:63], v12, s[60:63], 0 offen offset:48 sc1
    buffer_load_dwordx4 v[16:19], v13, s[60:63], s6 offen offset:0 sc1
    buffer_load_dwordx4 v[20:23], v13, s[60:63], s6 offen offset:512 sc1
    buffer_load_dwordx4 v[24:27], v13, s[60:63], s6 offen offset:1024 sc1
    buffer_load_dwordx4 v[28:31], v13, s[60:63], s6 offen offset:1536 sc1
    s_waitcnt vmcnt(0)
    s_branch L_chk_a1
L_retry_ml:
    s_cmp_eq_u32 s27, 0
    s_cbranch_scc1 L_ok_ml
    s_sub_u32 s27, s27, 1
    s_sleep 4
    buffer_load_dwordx4 v[48:51], v12, s[60:63], s28 offen offset:0 sc1
    buffer_load_dwordx4 v[52:55], v12, s[60:63], s28 offen offset:16 sc1
    buffer_load_dwordx4 v[56:59], v12, s[60:63], s28 offen offset:32 sc1
    buffer_load_dwordx4 v[60:63], v12, s[60:63], s28 offen offset:48 sc1
    s_mov_b32 s4, 1050624
    buffer_load_dwordx4 v[64:67], off, s[60:63], s4 sc1
    s_waitcnt vmcnt(0)
    s_branch L_chk_ml
L_far_st1:
    buffer_store_dwordx4 v[40:43], v7, s[60:63], s31 offen sc1
    s_branch L_st_done1
L_far_o1:
    buffer_load_dwordx4 v[64:67], v13, s[60:63], s31 offen offset:0 sc1
    buffer_load_dwordx4 v[68:71], v13, s[60:63], s31 offen offset:512 sc1
    buffer_load_dwordx4 v[72:75], v13, s[60:63], s31 offen offset:1024 sc1
    buffer_load_dwordx4 v[76:79], v13, s[60:63], s31 offen offset:1536 sc1
    s_waitcnt vmcnt(0)
    s_branch L_chk_o1
L_code_end:
.section .rodata,"a"
.p2align 6
.amdhsa_kernel concat_heads__sliding_block_cached__gqa_block_cached__decode_kernel
  .amdhsa_next_free_vgpr 512
  .amdhsa_next_free_sgpr 102
  .amdhsa_accum_offset 256
  .amdhsa_group_segment_fixed_size 0
  .amdhsa_kernarg_size 104
  .amdhsa_user_sgpr_count 2
  .amdhsa_user_sgpr_kernarg_segment_ptr 1
  .amdhsa_system_sgpr_workgroup_id_x 1
.end_amdhsa_kernel
```
